```python
import torch

def _softmax(x, axis=-1):
    return torch.softmax(x, dim=axis)
def _gelu(x):
    return torch.nn.functional.gelu(x, approximate="tanh")
def _silu(x):
    return torch.nn.functional.silu(x)
def _sigmoid(x):
    return torch.sigmoid(x)
def _layernorm(x, axis=-1, eps=1e-5):
    m = x.mean(dim=axis, keepdim=True)
    v = x.var(dim=axis, keepdim=True, unbiased=False)
    return (x - m) / torch.sqrt(v + eps)
def _scatter_add(tgt, idx, src, axis=0):
    return tgt.clone().index_add_(axis, idx, src)
def _segment_sum(src, seg, n):
    out = torch.zeros((n,) + src.shape[1:], dtype=src.dtype)
    return out.index_add_(0, seg, src)
def _pad(x, pw):
    flat = tuple(v for pair in reversed(pw) for v in pair)
    return torch.nn.functional.pad(x, flat)

kernel_name = 'standalone__gqa_block_cached__near_ridge'

def setup_inputs():

    _w = (lambda a: (lambda t: t.to(torch.bfloat16) if t.is_floating_point() else t)(torch.as_tensor(a)))
    B, Sq, D = 16, 48, 512
    Hq, Hkv, Sk, Dh = 32, 8, 512, 128
    assert Hq % Hkv == 0, (Hq, Hkv)
    return {
        "x": _w((lambda *s: torch.randn(*s, dtype=torch.bfloat16) * 0.8)(B, Sq, D)),
        "k_cache": _w((lambda *s: torch.randn(*s, dtype=torch.bfloat16) * 0.8)(B, Hkv, Sk, Dh)),
        "v_cache": _w((lambda *s: torch.randn(*s, dtype=torch.bfloat16) * 0.05)(B, Hkv, Sk, Dh)),
        "wq": _w((lambda *s: torch.randn(*s, dtype=torch.bfloat16) * 0.8)(D, Hq * Dh) * (D ** -0.5)),
        "wo": _w((lambda *s: torch.randn(*s, dtype=torch.bfloat16) * 0.05)(Hq * Dh, D) * ((Hq * Dh) ** -0.5)),
    }

def reference(x, k_cache, v_cache, wq, wo):
    B, Sq, D = x.shape
    Hq, Dh = 32, 128
    Hkv = k_cache.shape[1]
    rep = Hq // Hkv
    q = (lambda x, *d: x.permute(*d))((x @ wq).reshape(B, Sq, Hq, Dh), 0, 2, 1, 3)
    k = (lambda x, n, axis: torch.repeat_interleave(x, n, dim=axis))(k_cache, rep, axis=1)
    v = (lambda x, n, axis: torch.repeat_interleave(x, n, dim=axis))(v_cache, rep, axis=1)
    scores = torch.einsum("bhqd,bhkd->bhqk", q, k) * (Dh ** -0.5)
    p = _softmax(scores, axis=-1)
    o = torch.einsum("bhqk,bhkd->bhqd", p, v)
    return (lambda x, *d: x.permute(*d))(o, 0, 2, 1, 3).reshape(B, Sq, Hq * Dh) @ wo
```

```asm
; @launch grid=(256,1,1) block=(512,1,1) lds=163840
.amdgcn_target "amdgcn-amd-amdhsa--gfx950"
.text
.globl standalone__gqa_block_cached__near_ridge_kernel
.p2align 8
.type standalone__gqa_block_cached__near_ridge_kernel,@function
standalone__gqa_block_cached__near_ridge_kernel:
    s_cmp_ge_u32 s2, 0x100
    s_cbranch_scc1 gqa_fused_end
    s_load_dwordx16 s[4:19], s[0:1], 0
    v_and_b32 v1, 63, v0
    v_lshrrev_b32 v12, 6, v0
    s_nop 0
    v_readfirstlane_b32 s40, v12
    v_and_b32 v2, 15, v1
    v_lshrrev_b32 v3, 4, v1
    v_lshlrev_b32 v9, 4, v1
    s_and_b32 s41, s2, 7
    s_lshr_b32 s51, s2, 3
    s_and_b32 s43, s51, 1
    s_lshr_b32 s42, s51, 1
    s_lshr_b32 s44, s40, 2
    s_and_b32 s45, s40, 3
    s_lshl_b32 s56, s41, 1
    s_add_u32 s56, s56, s43
    s_and_b32 s57, s42, 7
    s_mov_b32 s46, 0x5040100
    s_mov_b32 s47, 0x7060302
    s_mov_b32 s48, 0x3e0293ee
    s_mov_b32 s88, s48
    s_mov_b32 s89, s48
    s_mov_b32 s91, 0xbe0293ee
    s_waitcnt lgkmcnt(0)
    s_mul_i32 s51, s42, 0xc000
    s_add_u32 s20, s4, s51
    s_addc_u32 s21, s5, 0
    s_and_b32 s21, s21, 0xffff
    s_mov_b32 s22, 0xc000
    s_mov_b32 s23, 0x20000
    s_add_u32 s68, s14, s51
    s_addc_u32 s69, s15, 0
    s_and_b32 s69, s69, 0xffff
    s_mov_b32 s70, 0xc000
    s_mov_b32 s71, 0x20000
    s_lshl_b32 s51, s42, 3
    s_add_u32 s51, s51, s41
    s_lshl_b32 s51, s51, 17
    s_add_u32 s24, s6, s51
    s_addc_u32 s25, s7, 0
    s_and_b32 s25, s25, 0xffff
    s_mov_b32 s26, 0x20000
    s_mov_b32 s27, 0x20000
    s_add_u32 s28, s8, s51
    s_addc_u32 s29, s9, 0
    s_and_b32 s29, s29, 0xffff
    s_mov_b32 s30, 0x20000
    s_mov_b32 s31, 0x20000
    s_mov_b32 s32, s10
    s_and_b32 s33, s11, 0xffff
    s_mov_b32 s34, 0x400000
    s_mov_b32 s35, 0x20000
    s_mov_b32 s60, s12
    s_and_b32 s61, s13, 0xffff
    s_mov_b32 s62, 0x400000
    s_mov_b32 s63, 0x20000
    s_mov_b32 s64, s16
    s_and_b32 s65, s17, 0xffff
    s_mov_b32 s66, 0x100
    s_mov_b32 s67, 0x20000
    s_mul_i32 s51, s42, 0x180000
    s_add_u32 s36, s18, s51
    s_addc_u32 s37, s19, 0
    s_and_b32 s37, s37, 0xffff
    s_mov_b32 s38, 0x180000
    s_mov_b32 s39, 0x20000
    s_mul_i32 s51, s42, 0x1100
    s_add_u32 s51, s51, 0x2000000
    s_add_u32 s92, s18, s51
    s_addc_u32 s93, s19, 0
    s_and_b32 s93, s93, 0xffff
    s_mov_b32 s94, 64
    s_mov_b32 s95, 0x20000
    s_lshr_b32 s5, s42, 3
    s_xor_b32 s4, s42, s41
    s_xor_b32 s4, s4, s5
    s_and_b32 s4, s4, 7
    s_lshl_b32 s4, s4, 12
    s_mov_b32 vcc_lo, 0x00ff00ff
    s_mov_b32 vcc_hi, 0x00ff00ff
    s_cmp_ge_u32 s40, 4
    s_cbranch_scc1 gqa_fused_pathB
    v_lshrrev_b32 v12, 3, v2
    v_lshlrev_b32 v12, 18, v12
    v_lshl_add_u32 v12, v3, 16, v12
    v_and_b32 v13, 7, v2
    v_lshl_add_u32 v8, v13, 4, v12
    s_lshl_b32 s49, s56, 9
    s_lshl_b32 s51, s40, 7
    s_add_u32 s90, s49, s51
    s_add_u32 s49, s42, 0
    s_and_b32 s49, s49, 7
    s_lshl_b32 s49, s49, 19
    s_add_u32 s49, s49, s90
    buffer_load_dwordx4 v[40:43], v8, s[32:35], s49 offen
    s_add_u32 s49, s49, 0x2000
    buffer_load_dwordx4 v[44:47], v8, s[32:35], s49 offen
    s_add_u32 s49, s49, 0x2000
    buffer_load_dwordx4 v[48:51], v8, s[32:35], s49 offen
    s_add_u32 s49, s49, 0x2000
    buffer_load_dwordx4 v[52:55], v8, s[32:35], s49 offen
    s_add_u32 s49, s49, 0x2000
    buffer_load_dwordx4 v[56:59], v8, s[32:35], s49 offen
    s_add_u32 s49, s49, 0x2000
    buffer_load_dwordx4 v[60:63], v8, s[32:35], s49 offen
    s_add_u32 s49, s49, 0x2000
    buffer_load_dwordx4 v[64:67], v8, s[32:35], s49 offen
    s_add_u32 s49, s49, 0x2000
    buffer_load_dwordx4 v[68:71], v8, s[32:35], s49 offen
    s_add_u32 s49, s42, 1
    s_and_b32 s49, s49, 7
    s_lshl_b32 s49, s49, 19
    s_add_u32 s49, s49, s90
    buffer_load_dwordx4 v[72:75], v8, s[32:35], s49 offen
    s_add_u32 s49, s49, 0x2000
    buffer_load_dwordx4 v[76:79], v8, s[32:35], s49 offen
    s_add_u32 s49, s49, 0x2000
    buffer_load_dwordx4 v[80:83], v8, s[32:35], s49 offen
    s_add_u32 s49, s49, 0x2000
    buffer_load_dwordx4 v[84:87], v8, s[32:35], s49 offen
    s_add_u32 s49, s49, 0x2000
    buffer_load_dwordx4 v[88:91], v8, s[32:35], s49 offen
    s_add_u32 s49, s49, 0x2000
    buffer_load_dwordx4 v[92:95], v8, s[32:35], s49 offen
    s_add_u32 s49, s49, 0x2000
    buffer_load_dwordx4 v[96:99], v8, s[32:35], s49 offen
    s_add_u32 s49, s49, 0x2000
    buffer_load_dwordx4 v[100:103], v8, s[32:35], s49 offen
    v_and_b32 v13, 3, v2
    v_lshlrev_b32 v13, 15, v13
    v_lshrrev_b32 v36, 2, v2
    v_lshl_add_u32 v25, v36, 10, v13
    s_lshl_b32 s51, s42, 1
    s_add_u32 s51, s51, 0
    s_and_b32 s51, s51, 3
    s_lshl_b32 s51, s51, 2
    v_add_u32 v12, s51, v3
    v_xor_b32 v12, v12, v2
    v_lshl_add_u32 v26, v12, 4, v25
    s_lshl_b32 s51, s42, 1
    s_add_u32 s51, s51, 1
    s_and_b32 s51, s51, 3
    s_lshl_b32 s51, s51, 2
    v_add_u32 v12, s51, v3
    v_xor_b32 v12, v12, v2
    v_lshl_add_u32 v27, v12, 4, v25
    s_lshl_b32 s51, s42, 1
    s_add_u32 s51, s51, 2
    s_and_b32 s51, s51, 3
    s_lshl_b32 s51, s51, 2
    v_add_u32 v12, s51, v3
    v_xor_b32 v12, v12, v2
    v_lshl_add_u32 v28, v12, 4, v25
    s_lshl_b32 s51, s42, 1
    s_add_u32 s51, s51, 3
    s_and_b32 s51, s51, 3
    s_lshl_b32 s51, s51, 2
    v_add_u32 v12, s51, v3
    v_xor_b32 v12, v12, v2
    v_lshl_add_u32 v29, v12, 4, v25
    s_add_u32 s52, s42, 0
    s_and_b32 s52, s52, 6
    s_lshl_b32 s52, s52, 7
    s_add_u32 s96, s52, 0x5000
    s_add_u32 s52, s42, 1
    s_and_b32 s52, s52, 6
    s_lshl_b32 s52, s52, 7
    s_add_u32 s97, s52, 0x5000
    s_add_u32 s52, s42, 2
    s_and_b32 s52, s52, 6
    s_lshl_b32 s52, s52, 7
    s_add_u32 s98, s52, 0x5000
    s_add_u32 s52, s42, 3
    s_and_b32 s52, s52, 6
    s_lshl_b32 s52, s52, 7
    s_add_u32 s99, s52, 0x5000
    s_add_u32 s52, s42, 4
    s_and_b32 s52, s52, 6
    s_lshl_b32 s52, s52, 7
    s_add_u32 s100, s52, 0x5000
    s_add_u32 s52, s42, 5
    s_and_b32 s52, s52, 6
    s_lshl_b32 s52, s52, 7
    s_add_u32 s101, s52, 0x5000
    s_add_u32 s52, s42, 6
    s_and_b32 s52, s52, 6
    s_lshl_b32 s52, s52, 7
    s_add_u32 s88, s52, 0x5000
    s_add_u32 s52, s42, 7
    s_and_b32 s52, s52, 6
    s_lshl_b32 s52, s52, 7
    s_add_u32 s89, s52, 0x5000
    v_add_u32 v12, 0, v3
    v_lshlrev_b32 v12, 1, v12
    v_xor_b32 v12, v12, v2
    v_lshlrev_b32 v12, 4, v12
    v_lshl_add_u32 v10, v3, 8, v12
    v_add_u32 v12, 4, v3
    v_lshlrev_b32 v12, 1, v12
    v_xor_b32 v12, v12, v2
    v_lshlrev_b32 v12, 4, v12
    v_lshl_add_u32 v11, v3, 8, v12
    s_mul_i32 s51, s44, 0xf00
    s_add_u32 s51, s51, 0x26000
    v_mul_u32_u24 v24, 0x50, v2
    v_add_u32 v24, s51, v24
    s_lshl_b32 s52, s45, 4
    v_lshl_add_u32 v12, v3, 2, s52
    v_add_u32 v15, v12, v24
    s_and_b32 s51, s40, 1
    s_lshl_b32 s51, s51, 3
    v_and_b32 v12, 1, v3
    v_lshl_add_u32 v36, v12, 2, s51
    v_xor_b32 v36, v36, v2
    v_lshlrev_b32 v36, 4, v36
    v_lshl_add_u32 v14, v2, 8, v36
    v_lshrrev_b32 v12, 1, v3
    v_lshl_add_u32 v14, v12, 3, v14
    s_lshr_b32 s51, s40, 1
    s_mul_i32 s51, s51, 0x3000
    s_add_u32 s51, s51, 0x20000
    v_add_u32 v14, s51, v14
    s_barrier
    v_add_u32 v34, s96, v26
    ds_read_b128 v[216:219], v34
    ds_read_b128 v[220:223], v34 offset:4096
    ds_read_b128 v[224:227], v34 offset:8192
    s_add_u32 s49, s42, 2
    s_and_b32 s49, s49, 7
    s_lshl_b32 s49, s49, 19
    s_add_u32 s49, s49, s90
    buffer_load_dwordx4 v[104:107], v8, s[32:35], s49 offen
    s_add_u32 s49, s49, 0x2000
    buffer_load_dwordx4 v[108:111], v8, s[32:35], s49 offen
    s_add_u32 s49, s49, 0x2000
    buffer_load_dwordx4 v[112:115], v8, s[32:35], s49 offen
    s_add_u32 s49, s49, 0x2000
    buffer_load_dwordx4 v[116:119], v8, s[32:35], s49 offen
    s_add_u32 s49, s49, 0x2000
    buffer_load_dwordx4 v[120:123], v8, s[32:35], s49 offen
    s_add_u32 s49, s49, 0x2000
    buffer_load_dwordx4 v[124:127], v8, s[32:35], s49 offen
    s_add_u32 s49, s49, 0x2000
    buffer_load_dwordx4 v[128:131], v8, s[32:35], s49 offen
    s_add_u32 s49, s49, 0x2000
    buffer_load_dwordx4 v[132:135], v8, s[32:35], s49 offen
    s_waitcnt vmcnt(16)
    v_cndmask_b32_dpp v30, v42, v40, vcc row_ror:8 row_mask:0xf bank_mask:0xf
    v_cndmask_b32_dpp v31, v46, v44, vcc row_ror:8 row_mask:0xf bank_mask:0xf
    v_perm_b32 v240, v31, v30, s46
    v_perm_b32 v244, v31, v30, s47
    v_cndmask_b32_dpp v32, v50, v48, vcc row_ror:8 row_mask:0xf bank_mask:0xf
    v_cndmask_b32_dpp v33, v54, v52, vcc row_ror:8 row_mask:0xf bank_mask:0xf
    v_perm_b32 v241, v33, v32, s46
    v_perm_b32 v245, v33, v32, s47
    v_cndmask_b32_dpp v30, v58, v56, vcc row_ror:8 row_mask:0xf bank_mask:0xf
    v_cndmask_b32_dpp v31, v62, v60, vcc row_ror:8 row_mask:0xf bank_mask:0xf
    v_perm_b32 v242, v31, v30, s46
    v_perm_b32 v246, v31, v30, s47
    v_cndmask_b32_dpp v32, v66, v64, vcc row_ror:8 row_mask:0xf bank_mask:0xf
    v_cndmask_b32_dpp v33, v70, v68, vcc row_ror:8 row_mask:0xf bank_mask:0xf
    v_perm_b32 v243, v33, v32, s46
    v_perm_b32 v247, v33, v32, s47
    v_cndmask_b32_dpp v30, v43, v41, vcc row_ror:8 row_mask:0xf bank_mask:0xf
    v_cndmask_b32_dpp v31, v47, v45, vcc row_ror:8 row_mask:0xf bank_mask:0xf
    v_perm_b32 v248, v31, v30, s46
    v_perm_b32 v252, v31, v30, s47
    v_cndmask_b32_dpp v32, v51, v49, vcc row_ror:8 row_mask:0xf bank_mask:0xf
    v_cndmask_b32_dpp v33, v55, v53, vcc row_ror:8 row_mask:0xf bank_mask:0xf
    v_perm_b32 v249, v33, v32, s46
    v_perm_b32 v253, v33, v32, s47
    v_cndmask_b32_dpp v30, v59, v57, vcc row_ror:8 row_mask:0xf bank_mask:0xf
    v_cndmask_b32_dpp v31, v63, v61, vcc row_ror:8 row_mask:0xf bank_mask:0xf
    v_perm_b32 v250, v31, v30, s46
    v_perm_b32 v254, v31, v30, s47
    v_cndmask_b32_dpp v32, v67, v65, vcc row_ror:8 row_mask:0xf bank_mask:0xf
    v_cndmask_b32_dpp v33, v71, v69, vcc row_ror:8 row_mask:0xf bank_mask:0xf
    v_perm_b32 v251, v33, v32, s46
    v_perm_b32 v255, v33, v32, s47
    v_add_u32 v35, s96, v27
    ds_read_b128 v[228:231], v35
    ds_read_b128 v[232:235], v35 offset:4096
    ds_read_b128 v[236:239], v35 offset:8192
    s_add_u32 s49, s42, 3
    s_and_b32 s49, s49, 7
    s_lshl_b32 s49, s49, 19
    s_add_u32 s49, s49, s90
    buffer_load_dwordx4 v[136:139], v8, s[32:35], s49 offen
    s_add_u32 s49, s49, 0x2000
    buffer_load_dwordx4 v[140:143], v8, s[32:35], s49 offen
    s_add_u32 s49, s49, 0x2000
    buffer_load_dwordx4 v[144:147], v8, s[32:35], s49 offen
    s_add_u32 s49, s49, 0x2000
    buffer_load_dwordx4 v[148:151], v8, s[32:35], s49 offen
    s_add_u32 s49, s49, 0x2000
    buffer_load_dwordx4 v[152:155], v8, s[32:35], s49 offen
    s_add_u32 s49, s49, 0x2000
    buffer_load_dwordx4 v[156:159], v8, s[32:35], s49 offen
    s_add_u32 s49, s49, 0x2000
    buffer_load_dwordx4 v[160:163], v8, s[32:35], s49 offen
    s_add_u32 s49, s49, 0x2000
    buffer_load_dwordx4 v[164:167], v8, s[32:35], s49 offen
    s_waitcnt lgkmcnt(3)
    v_mfma_f32_16x16x32_bf16 v[168:171], v[240:243], v[216:219], 0
    v_mov_b32_dpp v42, v40 row_ror:8 row_mask:0xf bank_mask:0x3
    v_mov_b32_dpp v46, v44 row_ror:8 row_mask:0xf bank_mask:0x3
    v_perm_b32 v4, v46, v42, s46
    v_mfma_f32_16x16x32_bf16 v[172:175], v[240:243], v[220:223], 0
    v_perm_b32 v36, v46, v42, s47
    v_mov_b32_dpp v50, v48 row_ror:8 row_mask:0xf bank_mask:0x3
    v_mov_b32_dpp v54, v52 row_ror:8 row_mask:0xf bank_mask:0x3
    v_mfma_f32_16x16x32_bf16 v[176:179], v[240:243], v[224:227], 0
    v_perm_b32 v5, v54, v50, s46
    v_perm_b32 v37, v54, v50, s47
    v_mov_b32_dpp v58, v56 row_ror:8 row_mask:0xf bank_mask:0x3
    v_mfma_f32_16x16x32_bf16 v[180:183], v[244:247], v[216:219], 0
    v_mov_b32_dpp v62, v60 row_ror:8 row_mask:0xf bank_mask:0x3
    v_perm_b32 v6, v62, v58, s46
    v_perm_b32 v38, v62, v58, s47
    v_mfma_f32_16x16x32_bf16 v[184:187], v[244:247], v[220:223], 0
    v_mov_b32_dpp v66, v64 row_ror:8 row_mask:0xf bank_mask:0x3
    v_mov_b32_dpp v70, v68 row_ror:8 row_mask:0xf bank_mask:0x3
    v_perm_b32 v7, v70, v66, s46
    v_mfma_f32_16x16x32_bf16 v[188:191], v[244:247], v[224:227], 0
    v_perm_b32 v39, v70, v66, s47
    v_mov_b32_dpp v43, v41 row_ror:8 row_mask:0xf bank_mask:0x3
    v_mov_b32_dpp v47, v45 row_ror:8 row_mask:0xf bank_mask:0x3
    v_mfma_f32_16x16x32_bf16 v[192:195], v[248:251], v[216:219], 0
    v_perm_b32 v16, v47, v43, s46
    v_perm_b32 v20, v47, v43, s47
    v_mov_b32_dpp v51, v49 row_ror:8 row_mask:0xf bank_mask:0x3
    v_mfma_f32_16x16x32_bf16 v[196:199], v[248:251], v[220:223], 0
    v_mov_b32_dpp v55, v53 row_ror:8 row_mask:0xf bank_mask:0x3
    v_perm_b32 v17, v55, v51, s46
    v_perm_b32 v21, v55, v51, s47
    v_mfma_f32_16x16x32_bf16 v[200:203], v[248:251], v[224:227], 0
    v_mov_b32_dpp v59, v57 row_ror:8 row_mask:0xf bank_mask:0x3
    v_mov_b32_dpp v63, v61 row_ror:8 row_mask:0xf bank_mask:0x3
    v_perm_b32 v18, v63, v59, s46
    v_mfma_f32_16x16x32_bf16 v[204:207], v[252:255], v[216:219], 0
    v_perm_b32 v22, v63, v59, s47
    v_mov_b32_dpp v67, v65 row_ror:8 row_mask:0xf bank_mask:0x3
    v_mov_b32_dpp v71, v69 row_ror:8 row_mask:0xf bank_mask:0x3
    v_mfma_f32_16x16x32_bf16 v[208:211], v[252:255], v[220:223], 0
    v_perm_b32 v19, v71, v67, s46
    v_perm_b32 v23, v71, v67, s47
    v_mfma_f32_16x16x32_bf16 v[212:215], v[252:255], v[224:227], 0
    v_add_u32 v34, s97, v28
    ds_read_b128 v[216:219], v34
    ds_read_b128 v[220:223], v34 offset:4096
    ds_read_b128 v[224:227], v34 offset:8192
    s_waitcnt lgkmcnt(3)
    v_mfma_f32_16x16x32_bf16 v[168:171], v[4:7], v[228:231], v[168:171]
    s_waitcnt vmcnt(16)
    v_cndmask_b32_dpp v30, v74, v72, vcc row_ror:8 row_mask:0xf bank_mask:0xf
    v_cndmask_b32_dpp v31, v78, v76, vcc row_ror:8 row_mask:0xf bank_mask:0xf
    v_perm_b32 v240, v31, v30, s46
    v_mfma_f32_16x16x32_bf16 v[172:175], v[4:7], v[232:235], v[172:175]
    v_perm_b32 v244, v31, v30, s47
    v_cndmask_b32_dpp v32, v82, v80, vcc row_ror:8 row_mask:0xf bank_mask:0xf
    v_cndmask_b32_dpp v33, v86, v84, vcc row_ror:8 row_mask:0xf bank_mask:0xf
    v_mfma_f32_16x16x32_bf16 v[176:179], v[4:7], v[236:239], v[176:179]
    v_perm_b32 v241, v33, v32, s46
    v_perm_b32 v245, v33, v32, s47
    v_cndmask_b32_dpp v30, v90, v88, vcc row_ror:8 row_mask:0xf bank_mask:0xf
    v_mfma_f32_16x16x32_bf16 v[180:183], v[36:39], v[228:231], v[180:183]
    v_cndmask_b32_dpp v31, v94, v92, vcc row_ror:8 row_mask:0xf bank_mask:0xf
    v_perm_b32 v242, v31, v30, s46
    v_perm_b32 v246, v31, v30, s47
    v_mfma_f32_16x16x32_bf16 v[184:187], v[36:39], v[232:235], v[184:187]
    v_cndmask_b32_dpp v32, v98, v96, vcc row_ror:8 row_mask:0xf bank_mask:0xf
    v_cndmask_b32_dpp v33, v102, v100, vcc row_ror:8 row_mask:0xf bank_mask:0xf
    v_perm_b32 v243, v33, v32, s46
    v_mfma_f32_16x16x32_bf16 v[188:191], v[36:39], v[236:239], v[188:191]
    v_perm_b32 v247, v33, v32, s47
    v_cndmask_b32_dpp v30, v75, v73, vcc row_ror:8 row_mask:0xf bank_mask:0xf
    v_cndmask_b32_dpp v31, v79, v77, vcc row_ror:8 row_mask:0xf bank_mask:0xf
    v_mfma_f32_16x16x32_bf16 v[192:195], v[16:19], v[228:231], v[192:195]
    v_perm_b32 v248, v31, v30, s46
    v_perm_b32 v252, v31, v30, s47
    v_cndmask_b32_dpp v32, v83, v81, vcc row_ror:8 row_mask:0xf bank_mask:0xf
    v_mfma_f32_16x16x32_bf16 v[196:199], v[16:19], v[232:235], v[196:199]
    v_cndmask_b32_dpp v33, v87, v85, vcc row_ror:8 row_mask:0xf bank_mask:0xf
    v_perm_b32 v249, v33, v32, s46
    v_perm_b32 v253, v33, v32, s47
    v_mfma_f32_16x16x32_bf16 v[200:203], v[16:19], v[236:239], v[200:203]
    v_cndmask_b32_dpp v30, v91, v89, vcc row_ror:8 row_mask:0xf bank_mask:0xf
    v_cndmask_b32_dpp v31, v95, v93, vcc row_ror:8 row_mask:0xf bank_mask:0xf
    v_perm_b32 v250, v31, v30, s46
    v_mfma_f32_16x16x32_bf16 v[204:207], v[20:23], v[228:231], v[204:207]
    v_perm_b32 v254, v31, v30, s47
    v_cndmask_b32_dpp v32, v99, v97, vcc row_ror:8 row_mask:0xf bank_mask:0xf
    v_cndmask_b32_dpp v33, v103, v101, vcc row_ror:8 row_mask:0xf bank_mask:0xf
    v_mfma_f32_16x16x32_bf16 v[208:211], v[20:23], v[232:235], v[208:211]
    v_perm_b32 v251, v33, v32, s46
    v_perm_b32 v255, v33, v32, s47
    v_mfma_f32_16x16x32_bf16 v[212:215], v[20:23], v[236:239], v[212:215]
    v_add_u32 v35, s97, v29
    ds_read_b128 v[228:231], v35
    ds_read_b128 v[232:235], v35 offset:4096
    ds_read_b128 v[236:239], v35 offset:8192
    s_add_u32 s49, s42, 4
    s_and_b32 s49, s49, 7
    s_lshl_b32 s49, s49, 19
    s_add_u32 s49, s49, s90
    buffer_load_dwordx4 v[40:43], v8, s[32:35], s49 offen
    s_add_u32 s49, s49, 0x2000
    buffer_load_dwordx4 v[44:47], v8, s[32:35], s49 offen
    s_add_u32 s49, s49, 0x2000
    buffer_load_dwordx4 v[48:51], v8, s[32:35], s49 offen
    s_add_u32 s49, s49, 0x2000
    buffer_load_dwordx4 v[52:55], v8, s[32:35], s49 offen
    s_add_u32 s49, s49, 0x2000
    buffer_load_dwordx4 v[56:59], v8, s[32:35], s49 offen
    s_add_u32 s49, s49, 0x2000
    buffer_load_dwordx4 v[60:63], v8, s[32:35], s49 offen
    s_add_u32 s49, s49, 0x2000
    buffer_load_dwordx4 v[64:67], v8, s[32:35], s49 offen
    s_add_u32 s49, s49, 0x2000
    buffer_load_dwordx4 v[68:71], v8, s[32:35], s49 offen
    s_waitcnt lgkmcnt(3)
    v_mfma_f32_16x16x32_bf16 v[168:171], v[240:243], v[216:219], v[168:171]
    v_mov_b32_dpp v74, v72 row_ror:8 row_mask:0xf bank_mask:0x3
    v_mov_b32_dpp v78, v76 row_ror:8 row_mask:0xf bank_mask:0x3
    v_perm_b32 v4, v78, v74, s46
    v_mfma_f32_16x16x32_bf16 v[172:175], v[240:243], v[220:223], v[172:175]
    v_perm_b32 v36, v78, v74, s47
    v_mov_b32_dpp v82, v80 row_ror:8 row_mask:0xf bank_mask:0x3
    v_mov_b32_dpp v86, v84 row_ror:8 row_mask:0xf bank_mask:0x3
    v_mfma_f32_16x16x32_bf16 v[176:179], v[240:243], v[224:227], v[176:179]
    v_perm_b32 v5, v86, v82, s46
    v_perm_b32 v37, v86, v82, s47
    v_mov_b32_dpp v90, v88 row_ror:8 row_mask:0xf bank_mask:0x3
    v_mfma_f32_16x16x32_bf16 v[180:183], v[244:247], v[216:219], v[180:183]
    v_mov_b32_dpp v94, v92 row_ror:8 row_mask:0xf bank_mask:0x3
    v_perm_b32 v6, v94, v90, s46
    v_perm_b32 v38, v94, v90, s47
    v_mfma_f32_16x16x32_bf16 v[184:187], v[244:247], v[220:223], v[184:187]
    v_mov_b32_dpp v98, v96 row_ror:8 row_mask:0xf bank_mask:0x3
    v_mov_b32_dpp v102, v100 row_ror:8 row_mask:0xf bank_mask:0x3
    v_perm_b32 v7, v102, v98, s46
    v_mfma_f32_16x16x32_bf16 v[188:191], v[244:247], v[224:227], v[188:191]
    v_perm_b32 v39, v102, v98, s47
    v_mov_b32_dpp v75, v73 row_ror:8 row_mask:0xf bank_mask:0x3
    v_mov_b32_dpp v79, v77 row_ror:8 row_mask:0xf bank_mask:0x3
    v_mfma_f32_16x16x32_bf16 v[192:195], v[248:251], v[216:219], v[192:195]
    v_perm_b32 v16, v79, v75, s46
    v_perm_b32 v20, v79, v75, s47
    v_mov_b32_dpp v83, v81 row_ror:8 row_mask:0xf bank_mask:0x3
    v_mfma_f32_16x16x32_bf16 v[196:199], v[248:251], v[220:223], v[196:199]
    v_mov_b32_dpp v87, v85 row_ror:8 row_mask:0xf bank_mask:0x3
    v_perm_b32 v17, v87, v83, s46
    v_perm_b32 v21, v87, v83, s47
    v_mfma_f32_16x16x32_bf16 v[200:203], v[248:251], v[224:227], v[200:203]
    v_mov_b32_dpp v91, v89 row_ror:8 row_mask:0xf bank_mask:0x3
    v_mov_b32_dpp v95, v93 row_ror:8 row_mask:0xf bank_mask:0x3
    v_perm_b32 v18, v95, v91, s46
    v_mfma_f32_16x16x32_bf16 v[204:207], v[252:255], v[216:219], v[204:207]
    v_perm_b32 v22, v95, v91, s47
    v_mov_b32_dpp v99, v97 row_ror:8 row_mask:0xf bank_mask:0x3
    v_mov_b32_dpp v103, v101 row_ror:8 row_mask:0xf bank_mask:0x3
    v_mfma_f32_16x16x32_bf16 v[208:211], v[252:255], v[220:223], v[208:211]
    v_perm_b32 v19, v103, v99, s46
    v_perm_b32 v23, v103, v99, s47
    v_mfma_f32_16x16x32_bf16 v[212:215], v[252:255], v[224:227], v[212:215]
    v_add_u32 v34, s98, v26
    ds_read_b128 v[216:219], v34
    ds_read_b128 v[220:223], v34 offset:4096
    ds_read_b128 v[224:227], v34 offset:8192
    s_waitcnt lgkmcnt(3)
    v_mfma_f32_16x16x32_bf16 v[168:171], v[4:7], v[228:231], v[168:171]
    s_waitcnt vmcnt(16)
    v_cndmask_b32_dpp v30, v106, v104, vcc row_ror:8 row_mask:0xf bank_mask:0xf
    v_cndmask_b32_dpp v31, v110, v108, vcc row_ror:8 row_mask:0xf bank_mask:0xf
    v_perm_b32 v240, v31, v30, s46
    v_mfma_f32_16x16x32_bf16 v[172:175], v[4:7], v[232:235], v[172:175]
    v_perm_b32 v244, v31, v30, s47
    v_cndmask_b32_dpp v32, v114, v112, vcc row_ror:8 row_mask:0xf bank_mask:0xf
    v_cndmask_b32_dpp v33, v118, v116, vcc row_ror:8 row_mask:0xf bank_mask:0xf
    v_mfma_f32_16x16x32_bf16 v[176:179], v[4:7], v[236:239], v[176:179]
    v_perm_b32 v241, v33, v32, s46
    v_perm_b32 v245, v33, v32, s47
    v_cndmask_b32_dpp v30, v122, v120, vcc row_ror:8 row_mask:0xf bank_mask:0xf
    v_mfma_f32_16x16x32_bf16 v[180:183], v[36:39], v[228:231], v[180:183]
    v_cndmask_b32_dpp v31, v126, v124, vcc row_ror:8 row_mask:0xf bank_mask:0xf
    v_perm_b32 v242, v31, v30, s46
    v_perm_b32 v246, v31, v30, s47
    v_mfma_f32_16x16x32_bf16 v[184:187], v[36:39], v[232:235], v[184:187]
    v_cndmask_b32_dpp v32, v130, v128, vcc row_ror:8 row_mask:0xf bank_mask:0xf
    v_cndmask_b32_dpp v33, v134, v132, vcc row_ror:8 row_mask:0xf bank_mask:0xf
    v_perm_b32 v243, v33, v32, s46
    v_mfma_f32_16x16x32_bf16 v[188:191], v[36:39], v[236:239], v[188:191]
    v_perm_b32 v247, v33, v32, s47
    v_cndmask_b32_dpp v30, v107, v105, vcc row_ror:8 row_mask:0xf bank_mask:0xf
    v_cndmask_b32_dpp v31, v111, v109, vcc row_ror:8 row_mask:0xf bank_mask:0xf
    v_mfma_f32_16x16x32_bf16 v[192:195], v[16:19], v[228:231], v[192:195]
    v_perm_b32 v248, v31, v30, s46
    v_perm_b32 v252, v31, v30, s47
    v_cndmask_b32_dpp v32, v115, v113, vcc row_ror:8 row_mask:0xf bank_mask:0xf
    v_mfma_f32_16x16x32_bf16 v[196:199], v[16:19], v[232:235], v[196:199]
    v_cndmask_b32_dpp v33, v119, v117, vcc row_ror:8 row_mask:0xf bank_mask:0xf
    v_perm_b32 v249, v33, v32, s46
    v_perm_b32 v253, v33, v32, s47
    v_mfma_f32_16x16x32_bf16 v[200:203], v[16:19], v[236:239], v[200:203]
    v_cndmask_b32_dpp v30, v123, v121, vcc row_ror:8 row_mask:0xf bank_mask:0xf
    v_cndmask_b32_dpp v31, v127, v125, vcc row_ror:8 row_mask:0xf bank_mask:0xf
    v_perm_b32 v250, v31, v30, s46
    v_mfma_f32_16x16x32_bf16 v[204:207], v[20:23], v[228:231], v[204:207]
    v_perm_b32 v254, v31, v30, s47
    v_cndmask_b32_dpp v32, v131, v129, vcc row_ror:8 row_mask:0xf bank_mask:0xf
    v_cndmask_b32_dpp v33, v135, v133, vcc row_ror:8 row_mask:0xf bank_mask:0xf
    v_mfma_f32_16x16x32_bf16 v[208:211], v[20:23], v[232:235], v[208:211]
    v_perm_b32 v251, v33, v32, s46
    v_perm_b32 v255, v33, v32, s47
    v_mfma_f32_16x16x32_bf16 v[212:215], v[20:23], v[236:239], v[212:215]
    v_add_u32 v35, s98, v27
    ds_read_b128 v[228:231], v35
    ds_read_b128 v[232:235], v35 offset:4096
    ds_read_b128 v[236:239], v35 offset:8192
    s_add_u32 s49, s42, 5
    s_and_b32 s49, s49, 7
    s_lshl_b32 s49, s49, 19
    s_add_u32 s49, s49, s90
    buffer_load_dwordx4 v[72:75], v8, s[32:35], s49 offen
    s_add_u32 s49, s49, 0x2000
    buffer_load_dwordx4 v[76:79], v8, s[32:35], s49 offen
    s_add_u32 s49, s49, 0x2000
    buffer_load_dwordx4 v[80:83], v8, s[32:35], s49 offen
    s_add_u32 s49, s49, 0x2000
    buffer_load_dwordx4 v[84:87], v8, s[32:35], s49 offen
    s_add_u32 s49, s49, 0x2000
    buffer_load_dwordx4 v[88:91], v8, s[32:35], s49 offen
    s_add_u32 s49, s49, 0x2000
    buffer_load_dwordx4 v[92:95], v8, s[32:35], s49 offen
    s_add_u32 s49, s49, 0x2000
    buffer_load_dwordx4 v[96:99], v8, s[32:35], s49 offen
    s_add_u32 s49, s49, 0x2000
    buffer_load_dwordx4 v[100:103], v8, s[32:35], s49 offen
    s_waitcnt lgkmcnt(3)
    v_mfma_f32_16x16x32_bf16 v[168:171], v[240:243], v[216:219], v[168:171]
    v_mov_b32_dpp v106, v104 row_ror:8 row_mask:0xf bank_mask:0x3
    v_mov_b32_dpp v110, v108 row_ror:8 row_mask:0xf bank_mask:0x3
    v_perm_b32 v4, v110, v106, s46
    v_mfma_f32_16x16x32_bf16 v[172:175], v[240:243], v[220:223], v[172:175]
    v_perm_b32 v36, v110, v106, s47
    v_mov_b32_dpp v114, v112 row_ror:8 row_mask:0xf bank_mask:0x3
    v_mov_b32_dpp v118, v116 row_ror:8 row_mask:0xf bank_mask:0x3
    v_mfma_f32_16x16x32_bf16 v[176:179], v[240:243], v[224:227], v[176:179]
    v_perm_b32 v5, v118, v114, s46
    v_perm_b32 v37, v118, v114, s47
    v_mov_b32_dpp v122, v120 row_ror:8 row_mask:0xf bank_mask:0x3
    v_mfma_f32_16x16x32_bf16 v[180:183], v[244:247], v[216:219], v[180:183]
    v_mov_b32_dpp v126, v124 row_ror:8 row_mask:0xf bank_mask:0x3
    v_perm_b32 v6, v126, v122, s46
    v_perm_b32 v38, v126, v122, s47
    v_mfma_f32_16x16x32_bf16 v[184:187], v[244:247], v[220:223], v[184:187]
    v_mov_b32_dpp v130, v128 row_ror:8 row_mask:0xf bank_mask:0x3
    v_mov_b32_dpp v134, v132 row_ror:8 row_mask:0xf bank_mask:0x3
    v_perm_b32 v7, v134, v130, s46
    v_mfma_f32_16x16x32_bf16 v[188:191], v[244:247], v[224:227], v[188:191]
    v_perm_b32 v39, v134, v130, s47
    v_mov_b32_dpp v107, v105 row_ror:8 row_mask:0xf bank_mask:0x3
    v_mov_b32_dpp v111, v109 row_ror:8 row_mask:0xf bank_mask:0x3
    v_mfma_f32_16x16x32_bf16 v[192:195], v[248:251], v[216:219], v[192:195]
    v_perm_b32 v16, v111, v107, s46
    v_perm_b32 v20, v111, v107, s47
    v_mov_b32_dpp v115, v113 row_ror:8 row_mask:0xf bank_mask:0x3
    v_mfma_f32_16x16x32_bf16 v[196:199], v[248:251], v[220:223], v[196:199]
    v_mov_b32_dpp v119, v117 row_ror:8 row_mask:0xf bank_mask:0x3
    v_perm_b32 v17, v119, v115, s46
    v_perm_b32 v21, v119, v115, s47
    v_mfma_f32_16x16x32_bf16 v[200:203], v[248:251], v[224:227], v[200:203]
    v_mov_b32_dpp v123, v121 row_ror:8 row_mask:0xf bank_mask:0x3
    v_mov_b32_dpp v127, v125 row_ror:8 row_mask:0xf bank_mask:0x3
    v_perm_b32 v18, v127, v123, s46
    v_mfma_f32_16x16x32_bf16 v[204:207], v[252:255], v[216:219], v[204:207]
    v_perm_b32 v22, v127, v123, s47
    v_mov_b32_dpp v131, v129 row_ror:8 row_mask:0xf bank_mask:0x3
    v_mov_b32_dpp v135, v133 row_ror:8 row_mask:0xf bank_mask:0x3
    v_mfma_f32_16x16x32_bf16 v[208:211], v[252:255], v[220:223], v[208:211]
    v_perm_b32 v19, v135, v131, s46
    v_perm_b32 v23, v135, v131, s47
    v_mfma_f32_16x16x32_bf16 v[212:215], v[252:255], v[224:227], v[212:215]
    v_add_u32 v34, s99, v28
    ds_read_b128 v[216:219], v34
    ds_read_b128 v[220:223], v34 offset:4096
    ds_read_b128 v[224:227], v34 offset:8192
    s_waitcnt lgkmcnt(3)
    v_mfma_f32_16x16x32_bf16 v[168:171], v[4:7], v[228:231], v[168:171]
    s_waitcnt vmcnt(16)
    v_cndmask_b32_dpp v30, v138, v136, vcc row_ror:8 row_mask:0xf bank_mask:0xf
    v_cndmask_b32_dpp v31, v142, v140, vcc row_ror:8 row_mask:0xf bank_mask:0xf
    v_perm_b32 v240, v31, v30, s46
    v_mfma_f32_16x16x32_bf16 v[172:175], v[4:7], v[232:235], v[172:175]
    v_perm_b32 v244, v31, v30, s47
    v_cndmask_b32_dpp v32, v146, v144, vcc row_ror:8 row_mask:0xf bank_mask:0xf
    v_cndmask_b32_dpp v33, v150, v148, vcc row_ror:8 row_mask:0xf bank_mask:0xf
    v_mfma_f32_16x16x32_bf16 v[176:179], v[4:7], v[236:239], v[176:179]
    v_perm_b32 v241, v33, v32, s46
    v_perm_b32 v245, v33, v32, s47
    v_cndmask_b32_dpp v30, v154, v152, vcc row_ror:8 row_mask:0xf bank_mask:0xf
    v_mfma_f32_16x16x32_bf16 v[180:183], v[36:39], v[228:231], v[180:183]
    v_cndmask_b32_dpp v31, v158, v156, vcc row_ror:8 row_mask:0xf bank_mask:0xf
    v_perm_b32 v242, v31, v30, s46
    v_perm_b32 v246, v31, v30, s47
    v_mfma_f32_16x16x32_bf16 v[184:187], v[36:39], v[232:235], v[184:187]
    v_cndmask_b32_dpp v32, v162, v160, vcc row_ror:8 row_mask:0xf bank_mask:0xf
    v_cndmask_b32_dpp v33, v166, v164, vcc row_ror:8 row_mask:0xf bank_mask:0xf
    v_perm_b32 v243, v33, v32, s46
    v_mfma_f32_16x16x32_bf16 v[188:191], v[36:39], v[236:239], v[188:191]
    v_perm_b32 v247, v33, v32, s47
    v_cndmask_b32_dpp v30, v139, v137, vcc row_ror:8 row_mask:0xf bank_mask:0xf
    v_cndmask_b32_dpp v31, v143, v141, vcc row_ror:8 row_mask:0xf bank_mask:0xf
    v_mfma_f32_16x16x32_bf16 v[192:195], v[16:19], v[228:231], v[192:195]
    v_perm_b32 v248, v31, v30, s46
    v_perm_b32 v252, v31, v30, s47
    v_cndmask_b32_dpp v32, v147, v145, vcc row_ror:8 row_mask:0xf bank_mask:0xf
    v_mfma_f32_16x16x32_bf16 v[196:199], v[16:19], v[232:235], v[196:199]
    v_cndmask_b32_dpp v33, v151, v149, vcc row_ror:8 row_mask:0xf bank_mask:0xf
    v_perm_b32 v249, v33, v32, s46
    v_perm_b32 v253, v33, v32, s47
    v_mfma_f32_16x16x32_bf16 v[200:203], v[16:19], v[236:239], v[200:203]
    v_cndmask_b32_dpp v30, v155, v153, vcc row_ror:8 row_mask:0xf bank_mask:0xf
    v_cndmask_b32_dpp v31, v159, v157, vcc row_ror:8 row_mask:0xf bank_mask:0xf
    v_perm_b32 v250, v31, v30, s46
    v_mfma_f32_16x16x32_bf16 v[204:207], v[20:23], v[228:231], v[204:207]
    v_perm_b32 v254, v31, v30, s47
    v_cndmask_b32_dpp v32, v163, v161, vcc row_ror:8 row_mask:0xf bank_mask:0xf
    v_cndmask_b32_dpp v33, v167, v165, vcc row_ror:8 row_mask:0xf bank_mask:0xf
    v_mfma_f32_16x16x32_bf16 v[208:211], v[20:23], v[232:235], v[208:211]
    v_perm_b32 v251, v33, v32, s46
    v_perm_b32 v255, v33, v32, s47
    v_mfma_f32_16x16x32_bf16 v[212:215], v[20:23], v[236:239], v[212:215]
    v_add_u32 v35, s99, v29
    ds_read_b128 v[228:231], v35
    ds_read_b128 v[232:235], v35 offset:4096
    ds_read_b128 v[236:239], v35 offset:8192
    s_add_u32 s49, s42, 6
    s_and_b32 s49, s49, 7
    s_lshl_b32 s49, s49, 19
    s_add_u32 s49, s49, s90
    buffer_load_dwordx4 v[104:107], v8, s[32:35], s49 offen
    s_add_u32 s49, s49, 0x2000
    buffer_load_dwordx4 v[108:111], v8, s[32:35], s49 offen
    s_add_u32 s49, s49, 0x2000
    buffer_load_dwordx4 v[112:115], v8, s[32:35], s49 offen
    s_add_u32 s49, s49, 0x2000
    buffer_load_dwordx4 v[116:119], v8, s[32:35], s49 offen
    s_add_u32 s49, s49, 0x2000
    buffer_load_dwordx4 v[120:123], v8, s[32:35], s49 offen
    s_add_u32 s49, s49, 0x2000
    buffer_load_dwordx4 v[124:127], v8, s[32:35], s49 offen
    s_add_u32 s49, s49, 0x2000
    buffer_load_dwordx4 v[128:131], v8, s[32:35], s49 offen
    s_add_u32 s49, s49, 0x2000
    buffer_load_dwordx4 v[132:135], v8, s[32:35], s49 offen
    s_waitcnt lgkmcnt(3)
    v_mfma_f32_16x16x32_bf16 v[168:171], v[240:243], v[216:219], v[168:171]
    v_mov_b32_dpp v138, v136 row_ror:8 row_mask:0xf bank_mask:0x3
    v_mov_b32_dpp v142, v140 row_ror:8 row_mask:0xf bank_mask:0x3
    v_perm_b32 v4, v142, v138, s46
    v_mfma_f32_16x16x32_bf16 v[172:175], v[240:243], v[220:223], v[172:175]
    v_perm_b32 v36, v142, v138, s47
    v_mov_b32_dpp v146, v144 row_ror:8 row_mask:0xf bank_mask:0x3
    v_mov_b32_dpp v150, v148 row_ror:8 row_mask:0xf bank_mask:0x3
    v_mfma_f32_16x16x32_bf16 v[176:179], v[240:243], v[224:227], v[176:179]
    v_perm_b32 v5, v150, v146, s46
    v_perm_b32 v37, v150, v146, s47
    v_mov_b32_dpp v154, v152 row_ror:8 row_mask:0xf bank_mask:0x3
    v_mfma_f32_16x16x32_bf16 v[180:183], v[244:247], v[216:219], v[180:183]
    v_mov_b32_dpp v158, v156 row_ror:8 row_mask:0xf bank_mask:0x3
    v_perm_b32 v6, v158, v154, s46
    v_perm_b32 v38, v158, v154, s47
    v_mfma_f32_16x16x32_bf16 v[184:187], v[244:247], v[220:223], v[184:187]
    v_mov_b32_dpp v162, v160 row_ror:8 row_mask:0xf bank_mask:0x3
    v_mov_b32_dpp v166, v164 row_ror:8 row_mask:0xf bank_mask:0x3
    v_perm_b32 v7, v166, v162, s46
    v_mfma_f32_16x16x32_bf16 v[188:191], v[244:247], v[224:227], v[188:191]
    v_perm_b32 v39, v166, v162, s47
    v_mov_b32_dpp v139, v137 row_ror:8 row_mask:0xf bank_mask:0x3
    v_mov_b32_dpp v143, v141 row_ror:8 row_mask:0xf bank_mask:0x3
    v_mfma_f32_16x16x32_bf16 v[192:195], v[248:251], v[216:219], v[192:195]
    v_perm_b32 v16, v143, v139, s46
    v_perm_b32 v20, v143, v139, s47
    v_mov_b32_dpp v147, v145 row_ror:8 row_mask:0xf bank_mask:0x3
    v_mfma_f32_16x16x32_bf16 v[196:199], v[248:251], v[220:223], v[196:199]
    v_mov_b32_dpp v151, v149 row_ror:8 row_mask:0xf bank_mask:0x3
    v_perm_b32 v17, v151, v147, s46
    v_perm_b32 v21, v151, v147, s47
    v_mfma_f32_16x16x32_bf16 v[200:203], v[248:251], v[224:227], v[200:203]
    v_mov_b32_dpp v155, v153 row_ror:8 row_mask:0xf bank_mask:0x3
    v_mov_b32_dpp v159, v157 row_ror:8 row_mask:0xf bank_mask:0x3
    v_perm_b32 v18, v159, v155, s46
    v_mfma_f32_16x16x32_bf16 v[204:207], v[252:255], v[216:219], v[204:207]
    v_perm_b32 v22, v159, v155, s47
    v_mov_b32_dpp v163, v161 row_ror:8 row_mask:0xf bank_mask:0x3
    v_mov_b32_dpp v167, v165 row_ror:8 row_mask:0xf bank_mask:0x3
    v_mfma_f32_16x16x32_bf16 v[208:211], v[252:255], v[220:223], v[208:211]
    v_perm_b32 v19, v167, v163, s46
    v_perm_b32 v23, v167, v163, s47
    v_mfma_f32_16x16x32_bf16 v[212:215], v[252:255], v[224:227], v[212:215]
    s_barrier
    v_add_u32 v34, s100, v26
    ds_read_b128 v[216:219], v34
    ds_read_b128 v[220:223], v34 offset:4096
    ds_read_b128 v[224:227], v34 offset:8192
    s_waitcnt lgkmcnt(3)
    v_mfma_f32_16x16x32_bf16 v[168:171], v[4:7], v[228:231], v[168:171]
    s_waitcnt vmcnt(16)
    v_cndmask_b32_dpp v30, v42, v40, vcc row_ror:8 row_mask:0xf bank_mask:0xf
    v_cndmask_b32_dpp v31, v46, v44, vcc row_ror:8 row_mask:0xf bank_mask:0xf
    v_perm_b32 v240, v31, v30, s46
    v_mfma_f32_16x16x32_bf16 v[172:175], v[4:7], v[232:235], v[172:175]
    v_perm_b32 v244, v31, v30, s47
    v_cndmask_b32_dpp v32, v50, v48, vcc row_ror:8 row_mask:0xf bank_mask:0xf
    v_cndmask_b32_dpp v33, v54, v52, vcc row_ror:8 row_mask:0xf bank_mask:0xf
    v_mfma_f32_16x16x32_bf16 v[176:179], v[4:7], v[236:239], v[176:179]
    v_perm_b32 v241, v33, v32, s46
    v_perm_b32 v245, v33, v32, s47
    v_cndmask_b32_dpp v30, v58, v56, vcc row_ror:8 row_mask:0xf bank_mask:0xf
    v_mfma_f32_16x16x32_bf16 v[180:183], v[36:39], v[228:231], v[180:183]
    v_cndmask_b32_dpp v31, v62, v60, vcc row_ror:8 row_mask:0xf bank_mask:0xf
    v_perm_b32 v242, v31, v30, s46
    v_perm_b32 v246, v31, v30, s47
    v_mfma_f32_16x16x32_bf16 v[184:187], v[36:39], v[232:235], v[184:187]
    v_cndmask_b32_dpp v32, v66, v64, vcc row_ror:8 row_mask:0xf bank_mask:0xf
    v_cndmask_b32_dpp v33, v70, v68, vcc row_ror:8 row_mask:0xf bank_mask:0xf
    v_perm_b32 v243, v33, v32, s46
    v_mfma_f32_16x16x32_bf16 v[188:191], v[36:39], v[236:239], v[188:191]
    v_perm_b32 v247, v33, v32, s47
    v_cndmask_b32_dpp v30, v43, v41, vcc row_ror:8 row_mask:0xf bank_mask:0xf
    v_cndmask_b32_dpp v31, v47, v45, vcc row_ror:8 row_mask:0xf bank_mask:0xf
    v_mfma_f32_16x16x32_bf16 v[192:195], v[16:19], v[228:231], v[192:195]
    v_perm_b32 v248, v31, v30, s46
    v_perm_b32 v252, v31, v30, s47
    v_cndmask_b32_dpp v32, v51, v49, vcc row_ror:8 row_mask:0xf bank_mask:0xf
    v_mfma_f32_16x16x32_bf16 v[196:199], v[16:19], v[232:235], v[196:199]
    v_cndmask_b32_dpp v33, v55, v53, vcc row_ror:8 row_mask:0xf bank_mask:0xf
    v_perm_b32 v249, v33, v32, s46
    v_perm_b32 v253, v33, v32, s47
    v_mfma_f32_16x16x32_bf16 v[200:203], v[16:19], v[236:239], v[200:203]
    v_cndmask_b32_dpp v30, v59, v57, vcc row_ror:8 row_mask:0xf bank_mask:0xf
    v_cndmask_b32_dpp v31, v63, v61, vcc row_ror:8 row_mask:0xf bank_mask:0xf
    v_perm_b32 v250, v31, v30, s46
    v_mfma_f32_16x16x32_bf16 v[204:207], v[20:23], v[228:231], v[204:207]
    v_perm_b32 v254, v31, v30, s47
    v_cndmask_b32_dpp v32, v67, v65, vcc row_ror:8 row_mask:0xf bank_mask:0xf
    v_cndmask_b32_dpp v33, v71, v69, vcc row_ror:8 row_mask:0xf bank_mask:0xf
    v_mfma_f32_16x16x32_bf16 v[208:211], v[20:23], v[232:235], v[208:211]
    v_perm_b32 v251, v33, v32, s46
    v_perm_b32 v255, v33, v32, s47
    v_mfma_f32_16x16x32_bf16 v[212:215], v[20:23], v[236:239], v[212:215]
    v_add_u32 v35, s100, v27
    ds_read_b128 v[228:231], v35
    ds_read_b128 v[232:235], v35 offset:4096
    ds_read_b128 v[236:239], v35 offset:8192
    s_add_u32 s49, s42, 7
    s_and_b32 s49, s49, 7
    s_lshl_b32 s49, s49, 19
    s_add_u32 s49, s49, s90
    buffer_load_dwordx4 v[136:139], v8, s[32:35], s49 offen
    s_add_u32 s49, s49, 0x2000
    buffer_load_dwordx4 v[140:143], v8, s[32:35], s49 offen
    s_add_u32 s49, s49, 0x2000
    buffer_load_dwordx4 v[144:147], v8, s[32:35], s49 offen
    s_add_u32 s49, s49, 0x2000
    buffer_load_dwordx4 v[148:151], v8, s[32:35], s49 offen
    s_add_u32 s49, s49, 0x2000
    buffer_load_dwordx4 v[152:155], v8, s[32:35], s49 offen
    s_add_u32 s49, s49, 0x2000
    buffer_load_dwordx4 v[156:159], v8, s[32:35], s49 offen
    s_add_u32 s49, s49, 0x2000
    buffer_load_dwordx4 v[160:163], v8, s[32:35], s49 offen
    s_add_u32 s49, s49, 0x2000
    buffer_load_dwordx4 v[164:167], v8, s[32:35], s49 offen
    s_waitcnt lgkmcnt(3)
    v_mfma_f32_16x16x32_bf16 v[168:171], v[240:243], v[216:219], v[168:171]
    v_mov_b32_dpp v42, v40 row_ror:8 row_mask:0xf bank_mask:0x3
    v_mov_b32_dpp v46, v44 row_ror:8 row_mask:0xf bank_mask:0x3
    v_perm_b32 v4, v46, v42, s46
    v_mfma_f32_16x16x32_bf16 v[172:175], v[240:243], v[220:223], v[172:175]
    v_perm_b32 v36, v46, v42, s47
    v_mov_b32_dpp v50, v48 row_ror:8 row_mask:0xf bank_mask:0x3
    v_mov_b32_dpp v54, v52 row_ror:8 row_mask:0xf bank_mask:0x3
    v_mfma_f32_16x16x32_bf16 v[176:179], v[240:243], v[224:227], v[176:179]
    v_perm_b32 v5, v54, v50, s46
    v_perm_b32 v37, v54, v50, s47
    v_mov_b32_dpp v58, v56 row_ror:8 row_mask:0xf bank_mask:0x3
    v_mfma_f32_16x16x32_bf16 v[180:183], v[244:247], v[216:219], v[180:183]
    v_mov_b32_dpp v62, v60 row_ror:8 row_mask:0xf bank_mask:0x3
    v_perm_b32 v6, v62, v58, s46
    v_perm_b32 v38, v62, v58, s47
    v_mfma_f32_16x16x32_bf16 v[184:187], v[244:247], v[220:223], v[184:187]
    v_mov_b32_dpp v66, v64 row_ror:8 row_mask:0xf bank_mask:0x3
    v_mov_b32_dpp v70, v68 row_ror:8 row_mask:0xf bank_mask:0x3
    v_perm_b32 v7, v70, v66, s46
    v_mfma_f32_16x16x32_bf16 v[188:191], v[244:247], v[224:227], v[188:191]
    v_perm_b32 v39, v70, v66, s47
    v_mov_b32_dpp v43, v41 row_ror:8 row_mask:0xf bank_mask:0x3
    v_mov_b32_dpp v47, v45 row_ror:8 row_mask:0xf bank_mask:0x3
    v_mfma_f32_16x16x32_bf16 v[192:195], v[248:251], v[216:219], v[192:195]
    v_perm_b32 v16, v47, v43, s46
    v_perm_b32 v20, v47, v43, s47
    v_mov_b32_dpp v51, v49 row_ror:8 row_mask:0xf bank_mask:0x3
    v_mfma_f32_16x16x32_bf16 v[196:199], v[248:251], v[220:223], v[196:199]
    v_mov_b32_dpp v55, v53 row_ror:8 row_mask:0xf bank_mask:0x3
    v_perm_b32 v17, v55, v51, s46
    v_perm_b32 v21, v55, v51, s47
    v_mfma_f32_16x16x32_bf16 v[200:203], v[248:251], v[224:227], v[200:203]
    v_mov_b32_dpp v59, v57 row_ror:8 row_mask:0xf bank_mask:0x3
    v_mov_b32_dpp v63, v61 row_ror:8 row_mask:0xf bank_mask:0x3
    v_perm_b32 v18, v63, v59, s46
    v_mfma_f32_16x16x32_bf16 v[204:207], v[252:255], v[216:219], v[204:207]
    v_perm_b32 v22, v63, v59, s47
    v_mov_b32_dpp v67, v65 row_ror:8 row_mask:0xf bank_mask:0x3
    v_mov_b32_dpp v71, v69 row_ror:8 row_mask:0xf bank_mask:0x3
    v_mfma_f32_16x16x32_bf16 v[208:211], v[252:255], v[220:223], v[208:211]
    v_perm_b32 v19, v71, v67, s46
    v_perm_b32 v23, v71, v67, s47
    v_mfma_f32_16x16x32_bf16 v[212:215], v[252:255], v[224:227], v[212:215]
    v_add_u32 v34, s101, v28
    ds_read_b128 v[216:219], v34
    ds_read_b128 v[220:223], v34 offset:4096
    ds_read_b128 v[224:227], v34 offset:8192
    s_waitcnt lgkmcnt(3)
    v_mfma_f32_16x16x32_bf16 v[168:171], v[4:7], v[228:231], v[168:171]
    s_waitcnt vmcnt(16)
    v_cndmask_b32_dpp v30, v74, v72, vcc row_ror:8 row_mask:0xf bank_mask:0xf
    v_cndmask_b32_dpp v31, v78, v76, vcc row_ror:8 row_mask:0xf bank_mask:0xf
    v_perm_b32 v240, v31, v30, s46
    v_mfma_f32_16x16x32_bf16 v[172:175], v[4:7], v[232:235], v[172:175]
    v_perm_b32 v244, v31, v30, s47
    v_cndmask_b32_dpp v32, v82, v80, vcc row_ror:8 row_mask:0xf bank_mask:0xf
    v_cndmask_b32_dpp v33, v86, v84, vcc row_ror:8 row_mask:0xf bank_mask:0xf
    v_mfma_f32_16x16x32_bf16 v[176:179], v[4:7], v[236:239], v[176:179]
    v_perm_b32 v241, v33, v32, s46
    v_perm_b32 v245, v33, v32, s47
    v_cndmask_b32_dpp v30, v90, v88, vcc row_ror:8 row_mask:0xf bank_mask:0xf
    v_mfma_f32_16x16x32_bf16 v[180:183], v[36:39], v[228:231], v[180:183]
    v_cndmask_b32_dpp v31, v94, v92, vcc row_ror:8 row_mask:0xf bank_mask:0xf
    v_perm_b32 v242, v31, v30, s46
    v_perm_b32 v246, v31, v30, s47
    v_mfma_f32_16x16x32_bf16 v[184:187], v[36:39], v[232:235], v[184:187]
    v_cndmask_b32_dpp v32, v98, v96, vcc row_ror:8 row_mask:0xf bank_mask:0xf
    v_cndmask_b32_dpp v33, v102, v100, vcc row_ror:8 row_mask:0xf bank_mask:0xf
    v_perm_b32 v243, v33, v32, s46
    v_mfma_f32_16x16x32_bf16 v[188:191], v[36:39], v[236:239], v[188:191]
    v_perm_b32 v247, v33, v32, s47
    v_cndmask_b32_dpp v30, v75, v73, vcc row_ror:8 row_mask:0xf bank_mask:0xf
    v_cndmask_b32_dpp v31, v79, v77, vcc row_ror:8 row_mask:0xf bank_mask:0xf
    v_mfma_f32_16x16x32_bf16 v[192:195], v[16:19], v[228:231], v[192:195]
    v_perm_b32 v248, v31, v30, s46
    v_perm_b32 v252, v31, v30, s47
    v_cndmask_b32_dpp v32, v83, v81, vcc row_ror:8 row_mask:0xf bank_mask:0xf
    v_mfma_f32_16x16x32_bf16 v[196:199], v[16:19], v[232:235], v[196:199]
    v_cndmask_b32_dpp v33, v87, v85, vcc row_ror:8 row_mask:0xf bank_mask:0xf
    v_perm_b32 v249, v33, v32, s46
    v_perm_b32 v253, v33, v32, s47
    v_mfma_f32_16x16x32_bf16 v[200:203], v[16:19], v[236:239], v[200:203]
    v_cndmask_b32_dpp v30, v91, v89, vcc row_ror:8 row_mask:0xf bank_mask:0xf
    v_cndmask_b32_dpp v31, v95, v93, vcc row_ror:8 row_mask:0xf bank_mask:0xf
    v_perm_b32 v250, v31, v30, s46
    v_mfma_f32_16x16x32_bf16 v[204:207], v[20:23], v[228:231], v[204:207]
    v_perm_b32 v254, v31, v30, s47
    v_cndmask_b32_dpp v32, v99, v97, vcc row_ror:8 row_mask:0xf bank_mask:0xf
    v_cndmask_b32_dpp v33, v103, v101, vcc row_ror:8 row_mask:0xf bank_mask:0xf
    v_mfma_f32_16x16x32_bf16 v[208:211], v[20:23], v[232:235], v[208:211]
    v_perm_b32 v251, v33, v32, s46
    v_perm_b32 v255, v33, v32, s47
    v_mfma_f32_16x16x32_bf16 v[212:215], v[20:23], v[236:239], v[212:215]
    v_add_u32 v35, s101, v29
    ds_read_b128 v[228:231], v35
    ds_read_b128 v[232:235], v35 offset:4096
    ds_read_b128 v[236:239], v35 offset:8192
    s_waitcnt lgkmcnt(3)
    v_mfma_f32_16x16x32_bf16 v[168:171], v[240:243], v[216:219], v[168:171]
    v_mov_b32_dpp v74, v72 row_ror:8 row_mask:0xf bank_mask:0x3
    v_mov_b32_dpp v78, v76 row_ror:8 row_mask:0xf bank_mask:0x3
    v_perm_b32 v4, v78, v74, s46
    v_mfma_f32_16x16x32_bf16 v[172:175], v[240:243], v[220:223], v[172:175]
    v_perm_b32 v36, v78, v74, s47
    v_mov_b32_dpp v82, v80 row_ror:8 row_mask:0xf bank_mask:0x3
    v_mov_b32_dpp v86, v84 row_ror:8 row_mask:0xf bank_mask:0x3
    v_mfma_f32_16x16x32_bf16 v[176:179], v[240:243], v[224:227], v[176:179]
    v_perm_b32 v5, v86, v82, s46
    v_perm_b32 v37, v86, v82, s47
    v_mov_b32_dpp v90, v88 row_ror:8 row_mask:0xf bank_mask:0x3
    v_mfma_f32_16x16x32_bf16 v[180:183], v[244:247], v[216:219], v[180:183]
    v_mov_b32_dpp v94, v92 row_ror:8 row_mask:0xf bank_mask:0x3
    v_perm_b32 v6, v94, v90, s46
    v_perm_b32 v38, v94, v90, s47
    v_mfma_f32_16x16x32_bf16 v[184:187], v[244:247], v[220:223], v[184:187]
    v_mov_b32_dpp v98, v96 row_ror:8 row_mask:0xf bank_mask:0x3
    v_mov_b32_dpp v102, v100 row_ror:8 row_mask:0xf bank_mask:0x3
    v_perm_b32 v7, v102, v98, s46
    v_mfma_f32_16x16x32_bf16 v[188:191], v[244:247], v[224:227], v[188:191]
    v_perm_b32 v39, v102, v98, s47
    v_mov_b32_dpp v75, v73 row_ror:8 row_mask:0xf bank_mask:0x3
    v_mov_b32_dpp v79, v77 row_ror:8 row_mask:0xf bank_mask:0x3
    v_mfma_f32_16x16x32_bf16 v[192:195], v[248:251], v[216:219], v[192:195]
    v_perm_b32 v16, v79, v75, s46
    v_perm_b32 v20, v79, v75, s47
    v_mov_b32_dpp v83, v81 row_ror:8 row_mask:0xf bank_mask:0x3
    v_mfma_f32_16x16x32_bf16 v[196:199], v[248:251], v[220:223], v[196:199]
    v_mov_b32_dpp v87, v85 row_ror:8 row_mask:0xf bank_mask:0x3
    v_perm_b32 v17, v87, v83, s46
    v_perm_b32 v21, v87, v83, s47
    v_mfma_f32_16x16x32_bf16 v[200:203], v[248:251], v[224:227], v[200:203]
    v_mov_b32_dpp v91, v89 row_ror:8 row_mask:0xf bank_mask:0x3
    v_mov_b32_dpp v95, v93 row_ror:8 row_mask:0xf bank_mask:0x3
    v_perm_b32 v18, v95, v91, s46
    v_mfma_f32_16x16x32_bf16 v[204:207], v[252:255], v[216:219], v[204:207]
    v_perm_b32 v22, v95, v91, s47
    v_mov_b32_dpp v99, v97 row_ror:8 row_mask:0xf bank_mask:0x3
    v_mov_b32_dpp v103, v101 row_ror:8 row_mask:0xf bank_mask:0x3
    v_mfma_f32_16x16x32_bf16 v[208:211], v[252:255], v[220:223], v[208:211]
    v_perm_b32 v19, v103, v99, s46
    v_perm_b32 v23, v103, v99, s47
    v_mfma_f32_16x16x32_bf16 v[212:215], v[252:255], v[224:227], v[212:215]
    v_add_u32 v34, s88, v26
    ds_read_b128 v[216:219], v34
    ds_read_b128 v[220:223], v34 offset:4096
    ds_read_b128 v[224:227], v34 offset:8192
    s_waitcnt lgkmcnt(3)
    v_mfma_f32_16x16x32_bf16 v[168:171], v[4:7], v[228:231], v[168:171]
    s_waitcnt vmcnt(8)
    v_cndmask_b32_dpp v30, v106, v104, vcc row_ror:8 row_mask:0xf bank_mask:0xf
    v_cndmask_b32_dpp v31, v110, v108, vcc row_ror:8 row_mask:0xf bank_mask:0xf
    v_perm_b32 v240, v31, v30, s46
    v_mfma_f32_16x16x32_bf16 v[172:175], v[4:7], v[232:235], v[172:175]
    v_perm_b32 v244, v31, v30, s47
    v_cndmask_b32_dpp v32, v114, v112, vcc row_ror:8 row_mask:0xf bank_mask:0xf
    v_cndmask_b32_dpp v33, v118, v116, vcc row_ror:8 row_mask:0xf bank_mask:0xf
    v_mfma_f32_16x16x32_bf16 v[176:179], v[4:7], v[236:239], v[176:179]
    v_perm_b32 v241, v33, v32, s46
    v_perm_b32 v245, v33, v32, s47
    v_cndmask_b32_dpp v30, v122, v120, vcc row_ror:8 row_mask:0xf bank_mask:0xf
    v_mfma_f32_16x16x32_bf16 v[180:183], v[36:39], v[228:231], v[180:183]
    v_cndmask_b32_dpp v31, v126, v124, vcc row_ror:8 row_mask:0xf bank_mask:0xf
    v_perm_b32 v242, v31, v30, s46
    v_perm_b32 v246, v31, v30, s47
    v_mfma_f32_16x16x32_bf16 v[184:187], v[36:39], v[232:235], v[184:187]
    v_cndmask_b32_dpp v32, v130, v128, vcc row_ror:8 row_mask:0xf bank_mask:0xf
    v_cndmask_b32_dpp v33, v134, v132, vcc row_ror:8 row_mask:0xf bank_mask:0xf
    v_perm_b32 v243, v33, v32, s46
    v_mfma_f32_16x16x32_bf16 v[188:191], v[36:39], v[236:239], v[188:191]
    v_perm_b32 v247, v33, v32, s47
    v_cndmask_b32_dpp v30, v107, v105, vcc row_ror:8 row_mask:0xf bank_mask:0xf
    v_cndmask_b32_dpp v31, v111, v109, vcc row_ror:8 row_mask:0xf bank_mask:0xf
    v_mfma_f32_16x16x32_bf16 v[192:195], v[16:19], v[228:231], v[192:195]
    v_perm_b32 v248, v31, v30, s46
    v_perm_b32 v252, v31, v30, s47
    v_cndmask_b32_dpp v32, v115, v113, vcc row_ror:8 row_mask:0xf bank_mask:0xf
    v_mfma_f32_16x16x32_bf16 v[196:199], v[16:19], v[232:235], v[196:199]
    v_cndmask_b32_dpp v33, v119, v117, vcc row_ror:8 row_mask:0xf bank_mask:0xf
    v_perm_b32 v249, v33, v32, s46
    v_perm_b32 v253, v33, v32, s47
    v_mfma_f32_16x16x32_bf16 v[200:203], v[16:19], v[236:239], v[200:203]
    v_cndmask_b32_dpp v30, v123, v121, vcc row_ror:8 row_mask:0xf bank_mask:0xf
    v_cndmask_b32_dpp v31, v127, v125, vcc row_ror:8 row_mask:0xf bank_mask:0xf
    v_perm_b32 v250, v31, v30, s46
    v_mfma_f32_16x16x32_bf16 v[204:207], v[20:23], v[228:231], v[204:207]
    v_perm_b32 v254, v31, v30, s47
    v_cndmask_b32_dpp v32, v131, v129, vcc row_ror:8 row_mask:0xf bank_mask:0xf
    v_cndmask_b32_dpp v33, v135, v133, vcc row_ror:8 row_mask:0xf bank_mask:0xf
    v_mfma_f32_16x16x32_bf16 v[208:211], v[20:23], v[232:235], v[208:211]
    v_perm_b32 v251, v33, v32, s46
    v_perm_b32 v255, v33, v32, s47
    v_mfma_f32_16x16x32_bf16 v[212:215], v[20:23], v[236:239], v[212:215]
    v_add_u32 v35, s88, v27
    ds_read_b128 v[228:231], v35
    ds_read_b128 v[232:235], v35 offset:4096
    ds_read_b128 v[236:239], v35 offset:8192
    s_waitcnt lgkmcnt(3)
    v_mfma_f32_16x16x32_bf16 v[168:171], v[240:243], v[216:219], v[168:171]
    v_mov_b32_dpp v106, v104 row_ror:8 row_mask:0xf bank_mask:0x3
    v_mov_b32_dpp v110, v108 row_ror:8 row_mask:0xf bank_mask:0x3
    v_perm_b32 v4, v110, v106, s46
    v_mfma_f32_16x16x32_bf16 v[172:175], v[240:243], v[220:223], v[172:175]
    v_perm_b32 v36, v110, v106, s47
    v_mov_b32_dpp v114, v112 row_ror:8 row_mask:0xf bank_mask:0x3
    v_mov_b32_dpp v118, v116 row_ror:8 row_mask:0xf bank_mask:0x3
    v_mfma_f32_16x16x32_bf16 v[176:179], v[240:243], v[224:227], v[176:179]
    v_perm_b32 v5, v118, v114, s46
    v_perm_b32 v37, v118, v114, s47
    v_mov_b32_dpp v122, v120 row_ror:8 row_mask:0xf bank_mask:0x3
    v_mfma_f32_16x16x32_bf16 v[180:183], v[244:247], v[216:219], v[180:183]
    v_mov_b32_dpp v126, v124 row_ror:8 row_mask:0xf bank_mask:0x3
    v_perm_b32 v6, v126, v122, s46
    v_perm_b32 v38, v126, v122, s47
    v_mfma_f32_16x16x32_bf16 v[184:187], v[244:247], v[220:223], v[184:187]
    v_mov_b32_dpp v130, v128 row_ror:8 row_mask:0xf bank_mask:0x3
    v_mov_b32_dpp v134, v132 row_ror:8 row_mask:0xf bank_mask:0x3
    v_perm_b32 v7, v134, v130, s46
    v_mfma_f32_16x16x32_bf16 v[188:191], v[244:247], v[224:227], v[188:191]
    v_perm_b32 v39, v134, v130, s47
    v_mov_b32_dpp v107, v105 row_ror:8 row_mask:0xf bank_mask:0x3
    v_mov_b32_dpp v111, v109 row_ror:8 row_mask:0xf bank_mask:0x3
    v_mfma_f32_16x16x32_bf16 v[192:195], v[248:251], v[216:219], v[192:195]
    v_perm_b32 v16, v111, v107, s46
    v_perm_b32 v20, v111, v107, s47
    v_mov_b32_dpp v115, v113 row_ror:8 row_mask:0xf bank_mask:0x3
    v_mfma_f32_16x16x32_bf16 v[196:199], v[248:251], v[220:223], v[196:199]
    v_mov_b32_dpp v119, v117 row_ror:8 row_mask:0xf bank_mask:0x3
    v_perm_b32 v17, v119, v115, s46
    v_perm_b32 v21, v119, v115, s47
    v_mfma_f32_16x16x32_bf16 v[200:203], v[248:251], v[224:227], v[200:203]
    v_mov_b32_dpp v123, v121 row_ror:8 row_mask:0xf bank_mask:0x3
    v_mov_b32_dpp v127, v125 row_ror:8 row_mask:0xf bank_mask:0x3
    v_perm_b32 v18, v127, v123, s46
    v_mfma_f32_16x16x32_bf16 v[204:207], v[252:255], v[216:219], v[204:207]
    v_perm_b32 v22, v127, v123, s47
    v_mov_b32_dpp v131, v129 row_ror:8 row_mask:0xf bank_mask:0x3
    v_mov_b32_dpp v135, v133 row_ror:8 row_mask:0xf bank_mask:0x3
    v_mfma_f32_16x16x32_bf16 v[208:211], v[252:255], v[220:223], v[208:211]
    v_perm_b32 v19, v135, v131, s46
    v_perm_b32 v23, v135, v131, s47
    v_mfma_f32_16x16x32_bf16 v[212:215], v[252:255], v[224:227], v[212:215]
    v_add_u32 v34, s89, v28
    ds_read_b128 v[216:219], v34
    ds_read_b128 v[220:223], v34 offset:4096
    ds_read_b128 v[224:227], v34 offset:8192
    s_waitcnt lgkmcnt(3)
    v_mfma_f32_16x16x32_bf16 v[168:171], v[4:7], v[228:231], v[168:171]
    s_waitcnt vmcnt(0)
    v_cndmask_b32_dpp v30, v138, v136, vcc row_ror:8 row_mask:0xf bank_mask:0xf
    v_cndmask_b32_dpp v31, v142, v140, vcc row_ror:8 row_mask:0xf bank_mask:0xf
    v_perm_b32 v240, v31, v30, s46
    v_mfma_f32_16x16x32_bf16 v[172:175], v[4:7], v[232:235], v[172:175]
    v_perm_b32 v244, v31, v30, s47
    v_cndmask_b32_dpp v32, v146, v144, vcc row_ror:8 row_mask:0xf bank_mask:0xf
    v_cndmask_b32_dpp v33, v150, v148, vcc row_ror:8 row_mask:0xf bank_mask:0xf
    v_mfma_f32_16x16x32_bf16 v[176:179], v[4:7], v[236:239], v[176:179]
    v_perm_b32 v241, v33, v32, s46
    v_perm_b32 v245, v33, v32, s47
    v_cndmask_b32_dpp v30, v154, v152, vcc row_ror:8 row_mask:0xf bank_mask:0xf
    v_mfma_f32_16x16x32_bf16 v[180:183], v[36:39], v[228:231], v[180:183]
    v_cndmask_b32_dpp v31, v158, v156, vcc row_ror:8 row_mask:0xf bank_mask:0xf
    v_perm_b32 v242, v31, v30, s46
    v_perm_b32 v246, v31, v30, s47
    v_mfma_f32_16x16x32_bf16 v[184:187], v[36:39], v[232:235], v[184:187]
    v_cndmask_b32_dpp v32, v162, v160, vcc row_ror:8 row_mask:0xf bank_mask:0xf
    v_cndmask_b32_dpp v33, v166, v164, vcc row_ror:8 row_mask:0xf bank_mask:0xf
    v_perm_b32 v243, v33, v32, s46
    v_mfma_f32_16x16x32_bf16 v[188:191], v[36:39], v[236:239], v[188:191]
    v_perm_b32 v247, v33, v32, s47
    v_cndmask_b32_dpp v30, v139, v137, vcc row_ror:8 row_mask:0xf bank_mask:0xf
    v_cndmask_b32_dpp v31, v143, v141, vcc row_ror:8 row_mask:0xf bank_mask:0xf
    v_mfma_f32_16x16x32_bf16 v[192:195], v[16:19], v[228:231], v[192:195]
    v_perm_b32 v248, v31, v30, s46
    v_perm_b32 v252, v31, v30, s47
    v_cndmask_b32_dpp v32, v147, v145, vcc row_ror:8 row_mask:0xf bank_mask:0xf
    v_mfma_f32_16x16x32_bf16 v[196:199], v[16:19], v[232:235], v[196:199]
    v_cndmask_b32_dpp v33, v151, v149, vcc row_ror:8 row_mask:0xf bank_mask:0xf
    v_perm_b32 v249, v33, v32, s46
    v_perm_b32 v253, v33, v32, s47
    v_mfma_f32_16x16x32_bf16 v[200:203], v[16:19], v[236:239], v[200:203]
    v_cndmask_b32_dpp v30, v155, v153, vcc row_ror:8 row_mask:0xf bank_mask:0xf
    v_cndmask_b32_dpp v31, v159, v157, vcc row_ror:8 row_mask:0xf bank_mask:0xf
    v_perm_b32 v250, v31, v30, s46
    v_mfma_f32_16x16x32_bf16 v[204:207], v[20:23], v[228:231], v[204:207]
    v_perm_b32 v254, v31, v30, s47
    v_cndmask_b32_dpp v32, v163, v161, vcc row_ror:8 row_mask:0xf bank_mask:0xf
    v_cndmask_b32_dpp v33, v167, v165, vcc row_ror:8 row_mask:0xf bank_mask:0xf
    v_mfma_f32_16x16x32_bf16 v[208:211], v[20:23], v[232:235], v[208:211]
    v_perm_b32 v251, v33, v32, s46
    v_perm_b32 v255, v33, v32, s47
    v_mfma_f32_16x16x32_bf16 v[212:215], v[20:23], v[236:239], v[212:215]
    v_add_u32 v35, s89, v29
    ds_read_b128 v[228:231], v35
    ds_read_b128 v[232:235], v35 offset:4096
    ds_read_b128 v[236:239], v35 offset:8192
    s_waitcnt lgkmcnt(3)
    v_mfma_f32_16x16x32_bf16 v[168:171], v[240:243], v[216:219], v[168:171]
    v_mov_b32_dpp v138, v136 row_ror:8 row_mask:0xf bank_mask:0x3
    v_mov_b32_dpp v142, v140 row_ror:8 row_mask:0xf bank_mask:0x3
    v_perm_b32 v4, v142, v138, s46
    v_mfma_f32_16x16x32_bf16 v[172:175], v[240:243], v[220:223], v[172:175]
    v_perm_b32 v36, v142, v138, s47
    v_mov_b32_dpp v146, v144 row_ror:8 row_mask:0xf bank_mask:0x3
    v_mov_b32_dpp v150, v148 row_ror:8 row_mask:0xf bank_mask:0x3
    v_mfma_f32_16x16x32_bf16 v[176:179], v[240:243], v[224:227], v[176:179]
    v_perm_b32 v5, v150, v146, s46
    v_perm_b32 v37, v150, v146, s47
    v_mov_b32_dpp v154, v152 row_ror:8 row_mask:0xf bank_mask:0x3
    v_mfma_f32_16x16x32_bf16 v[180:183], v[244:247], v[216:219], v[180:183]
    v_mov_b32_dpp v158, v156 row_ror:8 row_mask:0xf bank_mask:0x3
    v_perm_b32 v6, v158, v154, s46
    v_perm_b32 v38, v158, v154, s47
    v_mfma_f32_16x16x32_bf16 v[184:187], v[244:247], v[220:223], v[184:187]
    v_mov_b32_dpp v162, v160 row_ror:8 row_mask:0xf bank_mask:0x3
    v_mov_b32_dpp v166, v164 row_ror:8 row_mask:0xf bank_mask:0x3
    v_perm_b32 v7, v166, v162, s46
    v_mfma_f32_16x16x32_bf16 v[188:191], v[244:247], v[224:227], v[188:191]
    v_perm_b32 v39, v166, v162, s47
    v_mov_b32_dpp v139, v137 row_ror:8 row_mask:0xf bank_mask:0x3
    v_mov_b32_dpp v143, v141 row_ror:8 row_mask:0xf bank_mask:0x3
    v_mfma_f32_16x16x32_bf16 v[192:195], v[248:251], v[216:219], v[192:195]
    v_perm_b32 v16, v143, v139, s46
    v_perm_b32 v20, v143, v139, s47
    v_mov_b32_dpp v147, v145 row_ror:8 row_mask:0xf bank_mask:0x3
    v_mfma_f32_16x16x32_bf16 v[196:199], v[248:251], v[220:223], v[196:199]
    v_mov_b32_dpp v151, v149 row_ror:8 row_mask:0xf bank_mask:0x3
    v_perm_b32 v17, v151, v147, s46
    v_perm_b32 v21, v151, v147, s47
    v_mfma_f32_16x16x32_bf16 v[200:203], v[248:251], v[224:227], v[200:203]
    v_mov_b32_dpp v155, v153 row_ror:8 row_mask:0xf bank_mask:0x3
    v_mov_b32_dpp v159, v157 row_ror:8 row_mask:0xf bank_mask:0x3
    v_perm_b32 v18, v159, v155, s46
    v_mfma_f32_16x16x32_bf16 v[204:207], v[252:255], v[216:219], v[204:207]
    v_perm_b32 v22, v159, v155, s47
    v_mov_b32_dpp v163, v161 row_ror:8 row_mask:0xf bank_mask:0x3
    v_mov_b32_dpp v167, v165 row_ror:8 row_mask:0xf bank_mask:0x3
    v_mfma_f32_16x16x32_bf16 v[208:211], v[252:255], v[220:223], v[208:211]
    v_perm_b32 v19, v167, v163, s46
    v_perm_b32 v23, v167, v163, s47
    v_mfma_f32_16x16x32_bf16 v[212:215], v[252:255], v[224:227], v[212:215]
    s_waitcnt lgkmcnt(0)
    s_barrier
    v_mfma_f32_16x16x32_bf16 v[168:171], v[4:7], v[228:231], v[168:171]
    v_mfma_f32_16x16x32_bf16 v[172:175], v[4:7], v[232:235], v[172:175]
    v_mfma_f32_16x16x32_bf16 v[176:179], v[4:7], v[236:239], v[176:179]
    v_mfma_f32_16x16x32_bf16 v[180:183], v[36:39], v[228:231], v[180:183]
    v_mfma_f32_16x16x32_bf16 v[184:187], v[36:39], v[232:235], v[184:187]
    v_mfma_f32_16x16x32_bf16 v[188:191], v[36:39], v[236:239], v[188:191]
    v_mfma_f32_16x16x32_bf16 v[192:195], v[16:19], v[228:231], v[192:195]
    v_mfma_f32_16x16x32_bf16 v[196:199], v[16:19], v[232:235], v[196:199]
    v_mfma_f32_16x16x32_bf16 v[200:203], v[16:19], v[236:239], v[200:203]
    v_mfma_f32_16x16x32_bf16 v[204:207], v[20:23], v[228:231], v[204:207]
    v_mfma_f32_16x16x32_bf16 v[208:211], v[20:23], v[232:235], v[208:211]
    v_mfma_f32_16x16x32_bf16 v[212:215], v[20:23], v[236:239], v[212:215]
    v_xor_b32 v27, 16, v14
    v_xor_b32 v28, 32, v14
    v_xor_b32 v29, 48, v14
    v_cvt_pk_bf16_f32 v40, v168, v180
    s_nop 1
    v_cvt_pk_bf16_f32 v41, v192, v204
    ds_write_b64 v14, v[40:41]
    v_cvt_pk_bf16_f32 v42, v169, v181
    v_cvt_pk_bf16_f32 v43, v193, v205
    ds_write_b64 v27, v[42:43]
    v_cvt_pk_bf16_f32 v44, v170, v182
    v_cvt_pk_bf16_f32 v45, v194, v206
    ds_write_b64 v28, v[44:45]
    v_cvt_pk_bf16_f32 v46, v171, v183
    v_cvt_pk_bf16_f32 v47, v195, v207
    ds_write_b64 v29, v[46:47]
    v_cvt_pk_bf16_f32 v48, v172, v184
    v_cvt_pk_bf16_f32 v49, v196, v208
    ds_write_b64 v14, v[48:49] offset:4096
    v_cvt_pk_bf16_f32 v50, v173, v185
    v_cvt_pk_bf16_f32 v51, v197, v209
    ds_write_b64 v27, v[50:51] offset:4096
    v_cvt_pk_bf16_f32 v52, v174, v186
    v_cvt_pk_bf16_f32 v53, v198, v210
    ds_write_b64 v28, v[52:53] offset:4096
    v_cvt_pk_bf16_f32 v54, v175, v187
    v_cvt_pk_bf16_f32 v55, v199, v211
    ds_write_b64 v29, v[54:55] offset:4096
    v_cvt_pk_bf16_f32 v56, v176, v188
    v_cvt_pk_bf16_f32 v57, v200, v212
    ds_write_b64 v14, v[56:57] offset:8192
    v_cvt_pk_bf16_f32 v58, v177, v189
    v_cvt_pk_bf16_f32 v59, v201, v213
    ds_write_b64 v27, v[58:59] offset:8192
    v_cvt_pk_bf16_f32 v60, v178, v190
    v_cvt_pk_bf16_f32 v61, v202, v214
    ds_write_b64 v28, v[60:61] offset:8192
    v_cvt_pk_bf16_f32 v62, v179, v191
    v_cvt_pk_bf16_f32 v63, v203, v215
    ds_write_b64 v29, v[62:63] offset:8192
    s_waitcnt lgkmcnt(0)
    s_barrier
    s_branch gqa_fused_join
gqa_fused_pathB:
    s_sub_u32 s50, s40, 4
    s_cmp_lg_u32 s40, 4
    s_cbranch_scc1 gqa_fused_norst
    s_lshl_b32 s51, s56, 2
    v_mov_b32 v12, s51
    v_mov_b32 v13, 0
    s_mov_b64 exec, 1
    buffer_store_dword v13, v12, s[92:95], 0 offen sc1
    s_mov_b64 exec, -1
gqa_fused_norst:
    s_mul_i32 s51, s50, 12
    s_add_u32 s52, s51, 0
    s_and_b32 s54, s52, 15
    v_xor_b32 v12, s54, v1
    v_lshlrev_b32 v12, 4, v12
    s_and_b32 s54, s52, 3
    s_lshl_b32 s54, s54, 15
    s_lshr_b32 s55, s52, 2
    s_lshl_b32 s55, s55, 10
    s_add_u32 s54, s54, s55
    s_lshl_b32 s52, s52, 10
    s_add_u32 m0, s54, 0x5000
    s_nop 0
    buffer_load_dwordx4 v12, s[20:23], s52 offen lds
    s_add_u32 s52, s51, 1
    s_and_b32 s54, s52, 15
    v_xor_b32 v12, s54, v1
    v_lshlrev_b32 v12, 4, v12
    s_and_b32 s54, s52, 3
    s_lshl_b32 s54, s54, 15
    s_lshr_b32 s55, s52, 2
    s_lshl_b32 s55, s55, 10
    s_add_u32 s54, s54, s55
    s_lshl_b32 s52, s52, 10
    s_add_u32 m0, s54, 0x5000
    s_nop 0
    buffer_load_dwordx4 v12, s[20:23], s52 offen lds
    s_add_u32 s52, s51, 2
    s_and_b32 s54, s52, 15
    v_xor_b32 v12, s54, v1
    v_lshlrev_b32 v12, 4, v12
    s_and_b32 s54, s52, 3
    s_lshl_b32 s54, s54, 15
    s_lshr_b32 s55, s52, 2
    s_lshl_b32 s55, s55, 10
    s_add_u32 s54, s54, s55
    s_lshl_b32 s52, s52, 10
    s_add_u32 m0, s54, 0x5000
    s_nop 0
    buffer_load_dwordx4 v12, s[20:23], s52 offen lds
    s_add_u32 s52, s51, 3
    s_and_b32 s54, s52, 15
    v_xor_b32 v12, s54, v1
    v_lshlrev_b32 v12, 4, v12
    s_and_b32 s54, s52, 3
    s_lshl_b32 s54, s54, 15
    s_lshr_b32 s55, s52, 2
    s_lshl_b32 s55, s55, 10
    s_add_u32 s54, s54, s55
    s_lshl_b32 s52, s52, 10
    s_add_u32 m0, s54, 0x5000
    s_nop 0
    buffer_load_dwordx4 v12, s[20:23], s52 offen lds
    s_add_u32 s52, s51, 4
    s_and_b32 s54, s52, 15
    v_xor_b32 v12, s54, v1
    v_lshlrev_b32 v12, 4, v12
    s_and_b32 s54, s52, 3
    s_lshl_b32 s54, s54, 15
    s_lshr_b32 s55, s52, 2
    s_lshl_b32 s55, s55, 10
    s_add_u32 s54, s54, s55
    s_lshl_b32 s52, s52, 10
    s_add_u32 m0, s54, 0x5000
    s_nop 0
    buffer_load_dwordx4 v12, s[20:23], s52 offen lds
    s_add_u32 s52, s51, 5
    s_and_b32 s54, s52, 15
    v_xor_b32 v12, s54, v1
    v_lshlrev_b32 v12, 4, v12
    s_and_b32 s54, s52, 3
    s_lshl_b32 s54, s54, 15
    s_lshr_b32 s55, s52, 2
    s_lshl_b32 s55, s55, 10
    s_add_u32 s54, s54, s55
    s_lshl_b32 s52, s52, 10
    s_add_u32 m0, s54, 0x5000
    s_nop 0
    buffer_load_dwordx4 v12, s[20:23], s52 offen lds
    s_add_u32 s52, s51, 6
    s_and_b32 s54, s52, 15
    v_xor_b32 v12, s54, v1
    v_lshlrev_b32 v12, 4, v12
    s_and_b32 s54, s52, 3
    s_lshl_b32 s54, s54, 15
    s_lshr_b32 s55, s52, 2
    s_lshl_b32 s55, s55, 10
    s_add_u32 s54, s54, s55
    s_lshl_b32 s52, s52, 10
    s_add_u32 m0, s54, 0x5000
    s_nop 0
    buffer_load_dwordx4 v12, s[20:23], s52 offen lds
    s_add_u32 s52, s51, 7
    s_and_b32 s54, s52, 15
    v_xor_b32 v12, s54, v1
    v_lshlrev_b32 v12, 4, v12
    s_and_b32 s54, s52, 3
    s_lshl_b32 s54, s54, 15
    s_lshr_b32 s55, s52, 2
    s_lshl_b32 s55, s55, 10
    s_add_u32 s54, s54, s55
    s_lshl_b32 s52, s52, 10
    s_add_u32 m0, s54, 0x5000
    s_nop 0
    buffer_load_dwordx4 v12, s[20:23], s52 offen lds
    s_add_u32 s52, s51, 8
    s_and_b32 s54, s52, 15
    v_xor_b32 v12, s54, v1
    v_lshlrev_b32 v12, 4, v12
    s_and_b32 s54, s52, 3
    s_lshl_b32 s54, s54, 15
    s_lshr_b32 s55, s52, 2
    s_lshl_b32 s55, s55, 10
    s_add_u32 s54, s54, s55
    s_lshl_b32 s52, s52, 10
    s_add_u32 m0, s54, 0x5000
    s_nop 0
    buffer_load_dwordx4 v12, s[20:23], s52 offen lds
    s_add_u32 s52, s51, 9
    s_and_b32 s54, s52, 15
    v_xor_b32 v12, s54, v1
    v_lshlrev_b32 v12, 4, v12
    s_and_b32 s54, s52, 3
    s_lshl_b32 s54, s54, 15
    s_lshr_b32 s55, s52, 2
    s_lshl_b32 s55, s55, 10
    s_add_u32 s54, s54, s55
    s_lshl_b32 s52, s52, 10
    s_add_u32 m0, s54, 0x5000
    s_nop 0
    buffer_load_dwordx4 v12, s[20:23], s52 offen lds
    s_add_u32 s52, s51, 10
    s_and_b32 s54, s52, 15
    v_xor_b32 v12, s54, v1
    v_lshlrev_b32 v12, 4, v12
    s_and_b32 s54, s52, 3
    s_lshl_b32 s54, s54, 15
    s_lshr_b32 s55, s52, 2
    s_lshl_b32 s55, s55, 10
    s_add_u32 s54, s54, s55
    s_lshl_b32 s52, s52, 10
    s_add_u32 m0, s54, 0x5000
    s_nop 0
    buffer_load_dwordx4 v12, s[20:23], s52 offen lds
    s_add_u32 s52, s51, 11
    s_and_b32 s54, s52, 15
    v_xor_b32 v12, s54, v1
    v_lshlrev_b32 v12, 4, v12
    s_and_b32 s54, s52, 3
    s_lshl_b32 s54, s54, 15
    s_lshr_b32 s55, s52, 2
    s_lshl_b32 s55, s55, 10
    s_add_u32 s54, s54, s55
    s_lshl_b32 s52, s52, 10
    s_add_u32 m0, s54, 0x5000
    s_nop 0
    buffer_load_dwordx4 v12, s[20:23], s52 offen lds
    v_add_u32 v12, 0, v3
    v_xor_b32 v12, v12, v2
    v_lshlrev_b32 v12, 4, v12
    v_lshl_add_u32 v4, v3, 8, v12
    v_add_u32 v12, 4, v3
    v_xor_b32 v12, v12, v2
    v_lshlrev_b32 v12, 4, v12
    v_lshl_add_u32 v5, v3, 8, v12
    v_add_u32 v12, 8, v3
    v_xor_b32 v12, v12, v2
    v_lshlrev_b32 v12, 4, v12
    v_lshl_add_u32 v6, v3, 8, v12
    v_add_u32 v12, 12, v3
    v_xor_b32 v12, v12, v2
    v_lshlrev_b32 v12, 4, v12
    v_lshl_add_u32 v7, v3, 8, v12
    v_add_u32 v12, 0, v3
    v_lshlrev_b32 v12, 1, v12
    v_xor_b32 v12, v12, v2
    v_lshlrev_b32 v12, 4, v12
    v_lshl_add_u32 v10, v3, 8, v12
    v_add_u32 v12, 4, v3
    v_lshlrev_b32 v12, 1, v12
    v_xor_b32 v12, v12, v2
    v_lshlrev_b32 v12, 4, v12
    v_lshl_add_u32 v11, v3, 8, v12
    s_mul_i32 s51, s44, 0xf00
    s_add_u32 s51, s51, 0x26000
    v_mul_u32_u24 v24, 0x50, v2
    v_add_u32 v24, s51, v24
    s_lshl_b32 s52, s45, 4
    v_lshl_add_u32 v12, v3, 2, s52
    v_add_u32 v15, v12, v24
    s_waitcnt vmcnt(0)
    s_barrier
    s_cmp_lg_u32 s40, 4
    s_cbranch_scc1 gqa_fused_norst2
    s_lshl_b32 s51, s42, 4
    v_mov_b32 v12, s51
    v_mov_b32 v13, 1
    s_mov_b64 exec, 1
    buffer_atomic_add v13, v12, s[64:67], 0 offen sc1
    s_mov_b64 exec, -1
gqa_fused_norst2:
    s_barrier
    s_mul_i32 s55, s50, 0x8000
    s_add_u32 s55, s55, 0
    s_lshl_b32 s52, s50, 15
    s_add_u32 s52, s52, 0
    s_mov_b32 m0, s55
    s_xor_b32 s5, s52, s4
    buffer_load_dwordx4 v4, s[24:27], s5 offen nt lds
    s_add_u32 s52, s52, 0x400
    s_add_u32 s55, s55, 0x400
    s_mov_b32 m0, s55
    s_xor_b32 s5, s52, s4
    buffer_load_dwordx4 v5, s[24:27], s5 offen nt lds
    s_add_u32 s52, s52, 0x400
    s_add_u32 s55, s55, 0x400
    s_mov_b32 m0, s55
    s_xor_b32 s5, s52, s4
    buffer_load_dwordx4 v6, s[24:27], s5 offen nt lds
    s_add_u32 s52, s52, 0x400
    s_add_u32 s55, s55, 0x400
    s_mov_b32 m0, s55
    s_xor_b32 s5, s52, s4
    buffer_load_dwordx4 v7, s[24:27], s5 offen nt lds
    s_add_u32 s52, s52, 0x400
    s_add_u32 s55, s55, 0x400
    s_mov_b32 m0, s55
    s_xor_b32 s5, s52, s4
    buffer_load_dwordx4 v4, s[24:27], s5 offen nt lds
    s_add_u32 s52, s52, 0x400
    s_add_u32 s55, s55, 0x400
    s_mov_b32 m0, s55
    s_xor_b32 s5, s52, s4
    buffer_load_dwordx4 v5, s[24:27], s5 offen nt lds
    s_add_u32 s52, s52, 0x400
    s_add_u32 s55, s55, 0x400
    s_mov_b32 m0, s55
    s_xor_b32 s5, s52, s4
    buffer_load_dwordx4 v6, s[24:27], s5 offen nt lds
    s_add_u32 s52, s52, 0x400
    s_add_u32 s55, s55, 0x400
    s_mov_b32 m0, s55
    s_xor_b32 s5, s52, s4
    buffer_load_dwordx4 v7, s[24:27], s5 offen nt lds
    s_add_u32 s52, s52, 0x400
    s_add_u32 s55, s55, 0x400
    s_mov_b32 m0, s55
    s_xor_b32 s5, s52, s4
    buffer_load_dwordx4 v4, s[24:27], s5 offen nt lds
    s_add_u32 s52, s52, 0x400
    s_add_u32 s55, s55, 0x400
    s_mov_b32 m0, s55
    s_xor_b32 s5, s52, s4
    buffer_load_dwordx4 v5, s[24:27], s5 offen nt lds
    s_add_u32 s52, s52, 0x400
    s_add_u32 s55, s55, 0x400
    s_mov_b32 m0, s55
    s_xor_b32 s5, s52, s4
    buffer_load_dwordx4 v6, s[24:27], s5 offen nt lds
    s_add_u32 s52, s52, 0x400
    s_add_u32 s55, s55, 0x400
    s_mov_b32 m0, s55
    s_xor_b32 s5, s52, s4
    buffer_load_dwordx4 v7, s[24:27], s5 offen nt lds
    s_add_u32 s52, s52, 0x400
    s_add_u32 s55, s55, 0x400
    s_mov_b32 m0, s55
    s_xor_b32 s5, s52, s4
    buffer_load_dwordx4 v4, s[24:27], s5 offen nt lds
    s_add_u32 s52, s52, 0x400
    s_add_u32 s55, s55, 0x400
    s_mov_b32 m0, s55
    s_xor_b32 s5, s52, s4
    buffer_load_dwordx4 v5, s[24:27], s5 offen nt lds
    s_add_u32 s52, s52, 0x400
    s_add_u32 s55, s55, 0x400
    s_mov_b32 m0, s55
    s_xor_b32 s5, s52, s4
    buffer_load_dwordx4 v6, s[24:27], s5 offen nt lds
    s_add_u32 s52, s52, 0x400
    s_add_u32 s55, s55, 0x400
    s_mov_b32 m0, s55
    s_xor_b32 s5, s52, s4
    buffer_load_dwordx4 v7, s[24:27], s5 offen nt lds
    s_add_u32 s52, s52, 0x400
    s_add_u32 s55, s55, 0x400
    s_mov_b32 m0, s55
    s_xor_b32 s5, s52, s4
    buffer_load_dwordx4 v4, s[24:27], s5 offen nt lds
    s_add_u32 s52, s52, 0x400
    s_add_u32 s55, s55, 0x400
    s_mov_b32 m0, s55
    s_xor_b32 s5, s52, s4
    buffer_load_dwordx4 v5, s[24:27], s5 offen nt lds
    s_add_u32 s52, s52, 0x400
    s_add_u32 s55, s55, 0x400
    s_mov_b32 m0, s55
    s_xor_b32 s5, s52, s4
    buffer_load_dwordx4 v6, s[24:27], s5 offen nt lds
    s_add_u32 s52, s52, 0x400
    s_add_u32 s55, s55, 0x400
    s_mov_b32 m0, s55
    s_xor_b32 s5, s52, s4
    buffer_load_dwordx4 v7, s[24:27], s5 offen nt lds
    s_add_u32 s52, s52, 0x400
    s_add_u32 s55, s55, 0x400
    s_barrier
    s_mul_i32 s55, s50, 0x8000
    s_add_u32 s55, s55, 0x5000
    s_lshl_b32 s52, s50, 15
    s_add_u32 s52, s52, 0x5000
    s_mov_b32 m0, s55
    s_xor_b32 s5, s52, s4
    buffer_load_dwordx4 v4, s[24:27], s5 offen nt lds
    s_add_u32 s52, s52, 0x400
    s_add_u32 s55, s55, 0x400
    s_mov_b32 m0, s55
    s_xor_b32 s5, s52, s4
    buffer_load_dwordx4 v5, s[24:27], s5 offen nt lds
    s_add_u32 s52, s52, 0x400
    s_add_u32 s55, s55, 0x400
    s_mov_b32 m0, s55
    s_xor_b32 s5, s52, s4
    buffer_load_dwordx4 v6, s[24:27], s5 offen nt lds
    s_add_u32 s52, s52, 0x400
    s_add_u32 s55, s55, 0x400
    s_mov_b32 m0, s55
    s_xor_b32 s5, s52, s4
    buffer_load_dwordx4 v7, s[24:27], s5 offen nt lds
    s_add_u32 s52, s52, 0x400
    s_add_u32 s55, s55, 0x400
    s_mov_b32 m0, s55
    s_xor_b32 s5, s52, s4
    buffer_load_dwordx4 v4, s[24:27], s5 offen nt lds
    s_add_u32 s52, s52, 0x400
    s_add_u32 s55, s55, 0x400
    s_mov_b32 m0, s55
    s_xor_b32 s5, s52, s4
    buffer_load_dwordx4 v5, s[24:27], s5 offen nt lds
    s_add_u32 s52, s52, 0x400
    s_add_u32 s55, s55, 0x400
    s_mov_b32 m0, s55
    s_xor_b32 s5, s52, s4
    buffer_load_dwordx4 v6, s[24:27], s5 offen nt lds
    s_add_u32 s52, s52, 0x400
    s_add_u32 s55, s55, 0x400
    s_mov_b32 m0, s55
    s_xor_b32 s5, s52, s4
    buffer_load_dwordx4 v7, s[24:27], s5 offen nt lds
    s_add_u32 s52, s52, 0x400
    s_add_u32 s55, s55, 0x400
    s_mov_b32 m0, s55
    s_xor_b32 s5, s52, s4
    buffer_load_dwordx4 v4, s[24:27], s5 offen nt lds
    s_add_u32 s52, s52, 0x400
    s_add_u32 s55, s55, 0x400
    s_mov_b32 m0, s55
    s_xor_b32 s5, s52, s4
    buffer_load_dwordx4 v5, s[24:27], s5 offen nt lds
    s_add_u32 s52, s52, 0x400
    s_add_u32 s55, s55, 0x400
    s_mov_b32 m0, s55
    s_xor_b32 s5, s52, s4
    buffer_load_dwordx4 v6, s[24:27], s5 offen nt lds
    s_add_u32 s52, s52, 0x400
    s_add_u32 s55, s55, 0x400
    s_mov_b32 m0, s55
    s_xor_b32 s5, s52, s4
    buffer_load_dwordx4 v7, s[24:27], s5 offen nt lds
    s_add_u32 s52, s52, 0x400
    s_add_u32 s55, s55, 0x400
    s_waitcnt vmcnt(12)
    s_barrier
gqa_fused_join:
    v_mov_b32 v14, s48
    s_mul_i32 s51, s44, 0x3000
    s_add_u32 s51, s51, 0x20000
    s_lshl_b32 s52, s45, 15
    v_add_u32 v12, 0, v3
    v_xor_b32 v12, v12, v2
    v_lshlrev_b32 v12, 4, v12
    v_lshl_add_u32 v12, v2, 8, v12
    v_add_u32 v4, s51, v12
    v_add_u32 v37, s52, v12
    v_add_u32 v12, 4, v3
    v_xor_b32 v12, v12, v2
    v_lshlrev_b32 v12, 4, v12
    v_lshl_add_u32 v12, v2, 8, v12
    v_add_u32 v5, s51, v12
    v_add_u32 v38, s52, v12
    v_add_u32 v12, 8, v3
    v_xor_b32 v12, v12, v2
    v_lshlrev_b32 v12, 4, v12
    v_lshl_add_u32 v12, v2, 8, v12
    v_add_u32 v6, s51, v12
    v_add_u32 v39, s52, v12
    v_add_u32 v12, 12, v3
    v_xor_b32 v12, v12, v2
    v_lshlrev_b32 v12, 4, v12
    v_lshl_add_u32 v12, v2, 8, v12
    v_add_u32 v7, s51, v12
    v_add_u32 v8, s52, v12
    ds_read_b128 v[104:107], v4
    ds_read_b128 v[108:111], v5
    ds_read_b128 v[112:115], v6
    ds_read_b128 v[116:119], v7
    ds_read_b128 v[120:123], v4 offset:4096
    ds_read_b128 v[124:127], v5 offset:4096
    ds_read_b128 v[128:131], v6 offset:4096
    ds_read_b128 v[132:135], v7 offset:4096
    ds_read_b128 v[136:139], v4 offset:8192
    ds_read_b128 v[140:143], v5 offset:8192
    ds_read_b128 v[144:147], v6 offset:8192
    ds_read_b128 v[148:151], v7 offset:8192
    ds_read_b128 v[232:235], v37
    ds_read_b128 v[236:239], v38
    ds_read_b128 v[240:243], v39
    ds_read_b128 v[244:247], v8
    s_waitcnt lgkmcnt(4)
    s_waitcnt lgkmcnt(3)
    v_mfma_f32_16x16x32_bf16 v[160:163], v[232:235], v[104:107], 0
    v_mfma_f32_16x16x32_bf16 v[164:167], v[232:235], v[120:123], 0
    v_mfma_f32_16x16x32_bf16 v[168:171], v[232:235], v[136:139], 0
    ds_read_b128 v[248:251], v37 offset:4096
    s_lshl_b32 s53, s45, 15
    s_lshl_b32 s52, s44, 12
    s_add_u32 s53, s53, s52
    s_add_u32 s53, s53, 0x4000
    s_xor_b32 s53, s53, s4
    buffer_load_dwordx4 v[40:43], v9, s[28:31], s53 offen nt
    buffer_load_dwordx4 v[44:47], v9, s[28:31], s53 offen offset:1024 nt
    s_waitcnt lgkmcnt(3)
    v_mfma_f32_16x16x32_bf16 v[160:163], v[236:239], v[108:111], v[160:163]
    v_mfma_f32_16x16x32_bf16 v[164:167], v[236:239], v[124:127], v[164:167]
    v_mfma_f32_16x16x32_bf16 v[168:171], v[236:239], v[140:143], v[168:171]
    ds_read_b128 v[252:255], v38 offset:4096
    s_waitcnt lgkmcnt(3)
    v_mfma_f32_16x16x32_bf16 v[160:163], v[240:243], v[112:115], v[160:163]
    v_mfma_f32_16x16x32_bf16 v[164:167], v[240:243], v[128:131], v[164:167]
    v_mfma_f32_16x16x32_bf16 v[168:171], v[240:243], v[144:147], v[168:171]
    ds_read_b128 v[232:235], v39 offset:4096
    s_waitcnt lgkmcnt(3)
    v_mfma_f32_16x16x32_bf16 v[160:163], v[244:247], v[116:119], v[160:163]
    v_mfma_f32_16x16x32_bf16 v[164:167], v[244:247], v[132:135], v[164:167]
    v_mfma_f32_16x16x32_bf16 v[168:171], v[244:247], v[148:151], v[168:171]
    ds_read_b128 v[236:239], v8 offset:4096
    s_waitcnt lgkmcnt(3)
    v_mfma_f32_16x16x32_bf16 v[172:175], v[248:251], v[104:107], 0
    v_mfma_f32_16x16x32_bf16 v[176:179], v[248:251], v[120:123], 0
    v_mfma_f32_16x16x32_bf16 v[180:183], v[248:251], v[136:139], 0
    ds_read_b128 v[240:243], v37 offset:8192
    s_lshl_b32 s53, s45, 15
    s_lshl_b32 s52, s44, 12
    s_add_u32 s53, s53, s52
    s_add_u32 s53, s53, 0x4000
    s_xor_b32 s53, s53, s4
    buffer_load_dwordx4 v[48:51], v9, s[28:31], s53 offen offset:2048 nt
    buffer_load_dwordx4 v[52:55], v9, s[28:31], s53 offen offset:3072 nt
    s_waitcnt lgkmcnt(3)
    v_mfma_f32_16x16x32_bf16 v[172:175], v[252:255], v[108:111], v[172:175]
    v_mfma_f32_16x16x32_bf16 v[176:179], v[252:255], v[124:127], v[176:179]
    v_mfma_f32_16x16x32_bf16 v[180:183], v[252:255], v[140:143], v[180:183]
    ds_read_b128 v[244:247], v38 offset:8192
    s_waitcnt lgkmcnt(3)
    v_mfma_f32_16x16x32_bf16 v[172:175], v[232:235], v[112:115], v[172:175]
    v_mfma_f32_16x16x32_bf16 v[176:179], v[232:235], v[128:131], v[176:179]
    v_mfma_f32_16x16x32_bf16 v[180:183], v[232:235], v[144:147], v[180:183]
    ds_read_b128 v[248:251], v39 offset:8192
    s_waitcnt lgkmcnt(3)
    v_mfma_f32_16x16x32_bf16 v[172:175], v[236:239], v[116:119], v[172:175]
    v_mfma_f32_16x16x32_bf16 v[176:179], v[236:239], v[132:135], v[176:179]
    v_mfma_f32_16x16x32_bf16 v[180:183], v[236:239], v[148:151], v[180:183]
    ds_read_b128 v[252:255], v8 offset:8192
    s_waitcnt lgkmcnt(3)
    v_mfma_f32_16x16x32_bf16 v[184:187], v[240:243], v[104:107], 0
    v_mfma_f32_16x16x32_bf16 v[188:191], v[240:243], v[120:123], 0
    v_mfma_f32_16x16x32_bf16 v[192:195], v[240:243], v[136:139], 0
    ds_read_b128 v[232:235], v37 offset:12288
    s_lshl_b32 s53, s45, 15
    s_lshl_b32 s52, s44, 12
    s_add_u32 s53, s53, s52
    s_add_u32 s53, s53, 0x6000
    s_xor_b32 s53, s53, s4
    buffer_load_dwordx4 v[56:59], v9, s[28:31], s53 offen nt
    buffer_load_dwordx4 v[60:63], v9, s[28:31], s53 offen offset:1024 nt
    s_waitcnt lgkmcnt(3)
    v_mfma_f32_16x16x32_bf16 v[184:187], v[244:247], v[108:111], v[184:187]
    v_max3_f32 v30, v160, v161, v162
    v_max3_f32 v31, v164, v165, v166
    v_max3_f32 v32, v168, v169, v170
    v_mfma_f32_16x16x32_bf16 v[188:191], v[244:247], v[124:127], v[188:191]
    v_max3_f32 v30, v30, v163, v172
    v_max3_f32 v31, v31, v167, v176
    v_max3_f32 v32, v32, v171, v180
    v_mfma_f32_16x16x32_bf16 v[192:195], v[244:247], v[140:143], v[192:195]
    v_max3_f32 v30, v30, v173, v174
    v_max3_f32 v31, v31, v177, v178
    v_max3_f32 v32, v32, v181, v182
    ds_read_b128 v[236:239], v38 offset:12288
    s_waitcnt lgkmcnt(3)
    v_mfma_f32_16x16x32_bf16 v[184:187], v[248:251], v[112:115], v[184:187]
    v_max_f32 v30, v30, v175
    v_max_f32 v31, v31, v179
    v_max_f32 v32, v32, v183
    v_mfma_f32_16x16x32_bf16 v[188:191], v[248:251], v[128:131], v[188:191]
    v_mfma_f32_16x16x32_bf16 v[192:195], v[248:251], v[144:147], v[192:195]
    ds_read_b128 v[240:243], v39 offset:12288
    s_waitcnt lgkmcnt(3)
    v_mfma_f32_16x16x32_bf16 v[184:187], v[252:255], v[116:119], v[184:187]
    v_mfma_f32_16x16x32_bf16 v[188:191], v[252:255], v[132:135], v[188:191]
    v_mfma_f32_16x16x32_bf16 v[192:195], v[252:255], v[148:151], v[192:195]
    ds_read_b128 v[244:247], v8 offset:12288
    s_waitcnt lgkmcnt(3)
    v_mfma_f32_16x16x32_bf16 v[196:199], v[232:235], v[104:107], 0
    v_mfma_f32_16x16x32_bf16 v[200:203], v[232:235], v[120:123], 0
    v_mfma_f32_16x16x32_bf16 v[204:207], v[232:235], v[136:139], 0
    ds_read_b128 v[248:251], v37 offset:16384
    s_lshl_b32 s53, s45, 15
    s_lshl_b32 s52, s44, 12
    s_add_u32 s53, s53, s52
    s_add_u32 s53, s53, 0x6000
    s_xor_b32 s53, s53, s4
    buffer_load_dwordx4 v[64:67], v9, s[28:31], s53 offen offset:2048 nt
    buffer_load_dwordx4 v[68:71], v9, s[28:31], s53 offen offset:3072 nt
    s_waitcnt lgkmcnt(3)
    v_mfma_f32_16x16x32_bf16 v[196:199], v[236:239], v[108:111], v[196:199]
    v_mfma_f32_16x16x32_bf16 v[200:203], v[236:239], v[124:127], v[200:203]
    v_mfma_f32_16x16x32_bf16 v[204:207], v[236:239], v[140:143], v[204:207]
    ds_read_b128 v[252:255], v38 offset:16384
    s_waitcnt lgkmcnt(3)
    v_mfma_f32_16x16x32_bf16 v[196:199], v[240:243], v[112:115], v[196:199]
    v_mfma_f32_16x16x32_bf16 v[200:203], v[240:243], v[128:131], v[200:203]
    v_mfma_f32_16x16x32_bf16 v[204:207], v[240:243], v[144:147], v[204:207]
    ds_read_b128 v[232:235], v39 offset:16384
    s_waitcnt lgkmcnt(3)
    v_mfma_f32_16x16x32_bf16 v[196:199], v[244:247], v[116:119], v[196:199]
    v_mfma_f32_16x16x32_bf16 v[200:203], v[244:247], v[132:135], v[200:203]
    v_mfma_f32_16x16x32_bf16 v[204:207], v[244:247], v[148:151], v[204:207]
    ds_read_b128 v[236:239], v8 offset:16384
    s_waitcnt lgkmcnt(3)
    v_mfma_f32_16x16x32_bf16 v[208:211], v[248:251], v[104:107], 0
    v_mfma_f32_16x16x32_bf16 v[212:215], v[248:251], v[120:123], 0
    v_mfma_f32_16x16x32_bf16 v[216:219], v[248:251], v[136:139], 0
    s_cmp_lt_u32 s40, 4
    s_cbranch_scc1 gqa_fused_skip2c
    s_waitcnt vmcnt(8)
gqa_fused_skip2c:
    s_barrier
    s_lshl_b32 s51, s45, 15
    s_lshl_b32 s52, s44, 12
    s_add_u32 s51, s51, s52
    s_mov_b32 m0, s51
    s_xor_b32 s5, s51, s4
    buffer_load_dwordx4 v10, s[28:31], s5 offen nt lds
    s_add_u32 s51, s51, 0x400
    ds_read_b128 v[240:243], v37 offset:20480
    s_waitcnt lgkmcnt(3)
    v_mfma_f32_16x16x32_bf16 v[208:211], v[252:255], v[108:111], v[208:211]
    v_max3_f32 v30, v30, v184, v185
    v_max3_f32 v31, v31, v188, v189
    v_max3_f32 v32, v32, v192, v193
    v_mfma_f32_16x16x32_bf16 v[212:215], v[252:255], v[124:127], v[212:215]
    v_max3_f32 v30, v30, v186, v187
    v_max3_f32 v31, v31, v190, v191
    v_max3_f32 v32, v32, v194, v195
    v_mfma_f32_16x16x32_bf16 v[216:219], v[252:255], v[140:143], v[216:219]
    v_max3_f32 v30, v30, v196, v197
    v_max3_f32 v31, v31, v200, v201
    v_max3_f32 v32, v32, v204, v205
    ds_read_b128 v[244:247], v38 offset:20480
    s_waitcnt lgkmcnt(3)
    v_mfma_f32_16x16x32_bf16 v[208:211], v[232:235], v[112:115], v[208:211]
    v_max3_f32 v30, v30, v198, v199
    v_max3_f32 v31, v31, v202, v203
    v_max3_f32 v32, v32, v206, v207
    v_mfma_f32_16x16x32_bf16 v[212:215], v[232:235], v[128:131], v[212:215]
    v_mfma_f32_16x16x32_bf16 v[216:219], v[232:235], v[144:147], v[216:219]
    ds_read_b128 v[248:251], v39 offset:20480
    s_mov_b32 m0, s51
    s_xor_b32 s5, s51, s4
    buffer_load_dwordx4 v11, s[28:31], s5 offen nt lds
    s_add_u32 s51, s51, 0x400
    s_waitcnt lgkmcnt(3)
    v_mfma_f32_16x16x32_bf16 v[208:211], v[236:239], v[116:119], v[208:211]
    v_mfma_f32_16x16x32_bf16 v[212:215], v[236:239], v[132:135], v[212:215]
    v_mfma_f32_16x16x32_bf16 v[216:219], v[236:239], v[148:151], v[216:219]
    ds_read_b128 v[252:255], v8 offset:20480
    s_waitcnt lgkmcnt(3)
    v_mfma_f32_16x16x32_bf16 v[220:223], v[240:243], v[104:107], 0
    v_mfma_f32_16x16x32_bf16 v[224:227], v[240:243], v[120:123], 0
    v_mfma_f32_16x16x32_bf16 v[228:231], v[240:243], v[136:139], 0
    ds_read_b128 v[152:155], v37 offset:24576
    s_mov_b32 m0, s51
    s_xor_b32 s5, s51, s4
    buffer_load_dwordx4 v10, s[28:31], s5 offen nt lds
    s_add_u32 s51, s51, 0x400
    s_waitcnt lgkmcnt(3)
    v_mfma_f32_16x16x32_bf16 v[220:223], v[244:247], v[108:111], v[220:223]
    v_mfma_f32_16x16x32_bf16 v[224:227], v[244:247], v[124:127], v[224:227]
    v_mfma_f32_16x16x32_bf16 v[228:231], v[244:247], v[140:143], v[228:231]
    ds_read_b128 v[156:159], v38 offset:24576
    s_waitcnt lgkmcnt(3)
    v_mfma_f32_16x16x32_bf16 v[220:223], v[248:251], v[112:115], v[220:223]
    v_mfma_f32_16x16x32_bf16 v[224:227], v[248:251], v[128:131], v[224:227]
    v_mfma_f32_16x16x32_bf16 v[228:231], v[248:251], v[144:147], v[228:231]
    ds_read_b128 v[244:247], v39 offset:24576
    s_mov_b32 m0, s51
    s_xor_b32 s5, s51, s4
    buffer_load_dwordx4 v11, s[28:31], s5 offen nt lds
    s_add_u32 s51, s51, 0x1400
    s_waitcnt lgkmcnt(3)
    v_mfma_f32_16x16x32_bf16 v[220:223], v[252:255], v[116:119], v[220:223]
    v_mfma_f32_16x16x32_bf16 v[224:227], v[252:255], v[132:135], v[224:227]
    v_mfma_f32_16x16x32_bf16 v[228:231], v[252:255], v[148:151], v[228:231]
    ds_read_b128 v[248:251], v8 offset:24576
    s_waitcnt lgkmcnt(3)
    v_mfma_f32_16x16x32_bf16 v[232:235], v[152:155], v[104:107], 0
    v_mfma_f32_16x16x32_bf16 v[236:239], v[152:155], v[120:123], 0
    v_mfma_f32_16x16x32_bf16 v[240:243], v[152:155], v[136:139], 0
    ds_read_b128 v[152:155], v37 offset:28672
    s_mov_b32 m0, s51
    s_xor_b32 s5, s51, s4
    buffer_load_dwordx4 v10, s[28:31], s5 offen nt lds
    s_add_u32 s51, s51, 0x400
    s_waitcnt lgkmcnt(3)
    v_mfma_f32_16x16x32_bf16 v[232:235], v[156:159], v[108:111], v[232:235]
    v_max3_f32 v30, v30, v208, v209
    v_max3_f32 v31, v31, v212, v213
    v_max3_f32 v32, v32, v216, v217
    v_mfma_f32_16x16x32_bf16 v[236:239], v[156:159], v[124:127], v[236:239]
    v_max3_f32 v30, v30, v210, v211
    v_max3_f32 v31, v31, v214, v215
    v_max3_f32 v32, v32, v218, v219
    v_mfma_f32_16x16x32_bf16 v[240:243], v[156:159], v[140:143], v[240:243]
    v_max3_f32 v30, v30, v220, v221
    v_max3_f32 v31, v31, v224, v225
    v_max3_f32 v32, v32, v228, v229
    ds_read_b128 v[156:159], v38 offset:28672
    s_waitcnt lgkmcnt(3)
    v_mfma_f32_16x16x32_bf16 v[232:235], v[244:247], v[112:115], v[232:235]
    v_max3_f32 v30, v30, v222, v223
    v_max3_f32 v31, v31, v226, v227
    v_max3_f32 v32, v32, v230, v231
    v_mfma_f32_16x16x32_bf16 v[236:239], v[244:247], v[128:131], v[236:239]
    v_mfma_f32_16x16x32_bf16 v[240:243], v[244:247], v[144:147], v[240:243]
    s_mov_b32 m0, s51
    s_xor_b32 s5, s51, s4
    buffer_load_dwordx4 v11, s[28:31], s5 offen nt lds
    s_add_u32 s51, s51, 0x400
    s_waitcnt lgkmcnt(2)
    v_mfma_f32_16x16x32_bf16 v[232:235], v[248:251], v[116:119], v[232:235]
    v_mfma_f32_16x16x32_bf16 v[236:239], v[248:251], v[132:135], v[236:239]
    v_mfma_f32_16x16x32_bf16 v[240:243], v[248:251], v[148:151], v[240:243]
    s_waitcnt lgkmcnt(1)
    v_mfma_f32_16x16x32_bf16 v[244:247], v[152:155], v[104:107], 0
    v_mfma_f32_16x16x32_bf16 v[248:251], v[152:155], v[120:123], 0
    v_mfma_f32_16x16x32_bf16 v[252:255], v[152:155], v[136:139], 0
    s_mov_b32 m0, s51
    s_xor_b32 s5, s51, s4
    buffer_load_dwordx4 v10, s[28:31], s5 offen nt lds
    s_add_u32 s51, s51, 0x400
    ds_read_b128 v[152:155], v39 offset:28672
    s_waitcnt lgkmcnt(1)
    v_mfma_f32_16x16x32_bf16 v[244:247], v[156:159], v[108:111], v[244:247]
    v_mfma_f32_16x16x32_bf16 v[248:251], v[156:159], v[124:127], v[248:251]
    v_mfma_f32_16x16x32_bf16 v[252:255], v[156:159], v[140:143], v[252:255]
    ds_read_b128 v[156:159], v8 offset:28672
    s_waitcnt lgkmcnt(1)
    v_mfma_f32_16x16x32_bf16 v[244:247], v[152:155], v[112:115], v[244:247]
    v_mfma_f32_16x16x32_bf16 v[248:251], v[152:155], v[128:131], v[248:251]
    v_mfma_f32_16x16x32_bf16 v[252:255], v[152:155], v[144:147], v[252:255]
    s_mov_b32 m0, s51
    s_xor_b32 s5, s51, s4
    buffer_load_dwordx4 v11, s[28:31], s5 offen nt lds
    s_add_u32 s51, s51, 0x400
    s_waitcnt lgkmcnt(0)
    v_mfma_f32_16x16x32_bf16 v[244:247], v[156:159], v[116:119], v[244:247]
    v_mfma_f32_16x16x32_bf16 v[248:251], v[156:159], v[132:135], v[248:251]
    v_mfma_f32_16x16x32_bf16 v[252:255], v[156:159], v[148:151], v[252:255]
    v_max3_f32 v30, v30, v232, v233
    v_max3_f32 v31, v31, v236, v237
    v_max3_f32 v32, v32, v240, v241
    v_max3_f32 v30, v30, v234, v235
    v_max3_f32 v31, v31, v238, v239
    v_max3_f32 v32, v32, v242, v243
    v_max3_f32 v30, v30, v244, v245
    v_max3_f32 v31, v31, v248, v249
    v_max3_f32 v32, v32, v252, v253
    v_max3_f32 v30, v30, v246, v247
    v_max3_f32 v31, v31, v250, v251
    v_max3_f32 v32, v32, v254, v255
    ds_write_b32 v15, v30
    ds_write_b32 v15, v31 offset:1280
    ds_write_b32 v15, v32 offset:2560
    s_waitcnt lgkmcnt(0)
    s_barrier
    s_lshl_b32 s51, s56, 18
    s_lshl_b32 s52, s42, 14
    s_add_u32 s51, s51, s52
    s_lshl_b32 s52, s40, 11
    s_add_u32 s51, s51, s52
    buffer_load_dwordx4 v[4:7], v9, s[60:63], s51 offen
    buffer_load_dwordx4 v[4:7], v9, s[60:63], s51 offen offset:1024
    ds_read_b128 v[104:107], v24
    ds_read_b128 v[108:111], v24 offset:16
    ds_read_b128 v[112:115], v24 offset:32
    ds_read_b128 v[116:119], v24 offset:48
    ds_read_b128 v[120:123], v24 offset:1280
    ds_read_b128 v[124:127], v24 offset:1296
    ds_read_b128 v[128:131], v24 offset:1312
    ds_read_b128 v[132:135], v24 offset:1328
    ds_read_b128 v[136:139], v24 offset:2560
    ds_read_b128 v[140:143], v24 offset:2576
    ds_read_b128 v[144:147], v24 offset:2592
    ds_read_b128 v[148:151], v24 offset:2608
    s_lshl_b32 s51, s45, 15
    s_lshl_b32 s52, s44, 12
    s_add_u32 s52, s52, s51
    v_add_u32 v10, s52, v10
    v_add_u32 v11, s52, v11
    s_lshl_b32 s52, s44, 13
    s_add_u32 s52, s52, 0x4000
    v_add_u32 v37, s52, v9
    v_add_u32 v38, 0x10000, v37
    v_add_u32 v15, s51, v37
    s_mul_i32 s52, s44, 0x3000
    s_add_u32 s52, s52, 0x20000
    v_add_u32 v39, s52, v9
    s_mul_i32 s52, s45, 0xc00
    v_add_u32 v24, s52, v39
    s_add_u32 s52, s57, 0
    s_and_b32 s54, s52, 1
    s_lshl_b32 s54, s54, 16
    s_and_b32 s52, s52, 2
    s_lshl_b32 s52, s52, 12
    s_add_u32 s52, s52, s54
    s_add_u32 s96, s52, 0x4c00
    s_add_u32 s52, s57, 1
    s_and_b32 s54, s52, 1
    s_lshl_b32 s54, s54, 16
    s_and_b32 s52, s52, 2
    s_lshl_b32 s52, s52, 12
    s_add_u32 s52, s52, s54
    s_add_u32 s97, s52, 0x4c00
    s_add_u32 s52, s57, 2
    s_and_b32 s54, s52, 1
    s_lshl_b32 s54, s54, 16
    s_and_b32 s52, s52, 2
    s_lshl_b32 s52, s52, 12
    s_add_u32 s52, s52, s54
    s_add_u32 s98, s52, 0x4c00
    s_add_u32 s52, s57, 3
    s_and_b32 s54, s52, 1
    s_lshl_b32 s54, s54, 16
    s_and_b32 s52, s52, 2
    s_lshl_b32 s52, s52, 12
    s_add_u32 s52, s52, s54
    s_add_u32 s99, s52, 0x4c00
    s_waitcnt lgkmcnt(8)
    v_max3_f32 v33, v104, v105, v106
    v_max3_f32 v33, v33, v107, v108
    v_max3_f32 v33, v33, v109, v110
    v_max3_f32 v33, v33, v111, v112
    v_max3_f32 v33, v33, v113, v114
    v_max3_f32 v33, v33, v115, v116
    v_max3_f32 v33, v33, v117, v118
    v_max_f32 v33, v33, v119
    v_mul_f32 v33, s91, v33
    s_waitcnt lgkmcnt(4)
    v_max3_f32 v34, v120, v121, v122
    v_max3_f32 v34, v34, v123, v124
    v_max3_f32 v34, v34, v125, v126
    v_max3_f32 v34, v34, v127, v128
    v_max3_f32 v34, v34, v129, v130
    v_max3_f32 v34, v34, v131, v132
    v_max3_f32 v34, v34, v133, v134
    v_max_f32 v34, v34, v135
    v_mul_f32 v34, s91, v34
    s_waitcnt lgkmcnt(0)
    v_max3_f32 v35, v136, v137, v138
    v_max3_f32 v35, v35, v139, v140
    v_max3_f32 v35, v35, v141, v142
    v_max3_f32 v35, v35, v143, v144
    v_max3_f32 v35, v35, v145, v146
    v_max3_f32 v35, v35, v147, v148
    v_max3_f32 v35, v35, v149, v150
    v_max_f32 v35, v35, v151
    v_mul_f32 v35, s91, v35
    v_mov_b32 v128, 0x3f803f80
    v_mov_b32 v129, 0x3f803f80
    v_mov_b32 v130, 0x3f803f80
    v_mov_b32 v131, 0x3f803f80
    v_pk_fma_f32 v[160:161], v[160:161], v[14:15], v[32:33] op_sel:[0,0,1] op_sel_hi:[1,0,1]
    v_pk_fma_f32 v[162:163], v[162:163], v[14:15], v[32:33] op_sel:[0,0,1] op_sel_hi:[1,0,1]
    v_pk_fma_f32 v[172:173], v[172:173], v[14:15], v[32:33] op_sel:[0,0,1] op_sel_hi:[1,0,1]
    v_pk_fma_f32 v[174:175], v[174:175], v[14:15], v[32:33] op_sel:[0,0,1] op_sel_hi:[1,0,1]
    v_exp_f32 v160, v160
    v_exp_f32 v161, v161
    v_exp_f32 v162, v162
    v_exp_f32 v163, v163
    v_exp_f32 v172, v172
    v_exp_f32 v173, v173
    v_exp_f32 v174, v174
    v_exp_f32 v175, v175
    v_pk_fma_f32 v[164:165], v[164:165], v[14:15], v[34:35] op_sel:[0,0,0] op_sel_hi:[1,0,0]
    v_pk_fma_f32 v[166:167], v[166:167], v[14:15], v[34:35] op_sel:[0,0,0] op_sel_hi:[1,0,0]
    v_pk_fma_f32 v[176:177], v[176:177], v[14:15], v[34:35] op_sel:[0,0,0] op_sel_hi:[1,0,0]
    v_pk_fma_f32 v[178:179], v[178:179], v[14:15], v[34:35] op_sel:[0,0,0] op_sel_hi:[1,0,0]
    v_cvt_pk_bf16_f32 v160, v160, v161
    v_cvt_pk_bf16_f32 v161, v162, v163
    v_cvt_pk_bf16_f32 v162, v172, v173
    v_cvt_pk_bf16_f32 v163, v174, v175
    v_exp_f32 v164, v164
    v_exp_f32 v165, v165
    v_exp_f32 v166, v166
    v_exp_f32 v167, v167
    v_exp_f32 v176, v176
    v_exp_f32 v177, v177
    v_exp_f32 v178, v178
    v_exp_f32 v179, v179
    ds_write_b128 v15, v[160:163]
    v_mfma_f32_16x16x32_bf16 v[132:135], v[128:131], v[160:163], 0
    v_pk_fma_f32 v[168:169], v[168:169], v[14:15], v[34:35] op_sel:[0,0,1] op_sel_hi:[1,0,1]
    v_pk_fma_f32 v[170:171], v[170:171], v[14:15], v[34:35] op_sel:[0,0,1] op_sel_hi:[1,0,1]
    v_pk_fma_f32 v[180:181], v[180:181], v[14:15], v[34:35] op_sel:[0,0,1] op_sel_hi:[1,0,1]
    v_pk_fma_f32 v[182:183], v[182:183], v[14:15], v[34:35] op_sel:[0,0,1] op_sel_hi:[1,0,1]
    v_cvt_pk_bf16_f32 v164, v164, v165
    v_cvt_pk_bf16_f32 v165, v166, v167
    v_cvt_pk_bf16_f32 v166, v176, v177
    v_cvt_pk_bf16_f32 v167, v178, v179
    v_exp_f32 v168, v168
    v_exp_f32 v169, v169
    v_exp_f32 v170, v170
    v_exp_f32 v171, v171
    v_exp_f32 v180, v180
    v_exp_f32 v181, v181
    v_exp_f32 v182, v182
    v_exp_f32 v183, v183
    ds_write_b128 v15, v[164:167] offset:1024
    v_mfma_f32_16x16x32_bf16 v[136:139], v[128:131], v[164:167], 0
    v_cvt_pk_bf16_f32 v168, v168, v169
    v_cvt_pk_bf16_f32 v169, v170, v171
    v_cvt_pk_bf16_f32 v170, v180, v181
    v_cvt_pk_bf16_f32 v171, v182, v183
    ds_write_b128 v15, v[168:171] offset:2048
    s_nop 0
    v_mfma_f32_16x16x32_bf16 v[140:143], v[128:131], v[168:171], 0
    v_pk_fma_f32 v[184:185], v[184:185], v[14:15], v[32:33] op_sel:[0,0,1] op_sel_hi:[1,0,1]
    v_pk_fma_f32 v[186:187], v[186:187], v[14:15], v[32:33] op_sel:[0,0,1] op_sel_hi:[1,0,1]
    v_pk_fma_f32 v[196:197], v[196:197], v[14:15], v[32:33] op_sel:[0,0,1] op_sel_hi:[1,0,1]
    v_pk_fma_f32 v[198:199], v[198:199], v[14:15], v[32:33] op_sel:[0,0,1] op_sel_hi:[1,0,1]
    v_exp_f32 v184, v184
    v_exp_f32 v185, v185
    v_exp_f32 v186, v186
    v_exp_f32 v187, v187
    v_exp_f32 v196, v196
    v_exp_f32 v197, v197
    v_exp_f32 v198, v198
    v_exp_f32 v199, v199
    v_pk_fma_f32 v[188:189], v[188:189], v[14:15], v[34:35] op_sel:[0,0,0] op_sel_hi:[1,0,0]
    v_pk_fma_f32 v[190:191], v[190:191], v[14:15], v[34:35] op_sel:[0,0,0] op_sel_hi:[1,0,0]
    v_pk_fma_f32 v[200:201], v[200:201], v[14:15], v[34:35] op_sel:[0,0,0] op_sel_hi:[1,0,0]
    v_pk_fma_f32 v[202:203], v[202:203], v[14:15], v[34:35] op_sel:[0,0,0] op_sel_hi:[1,0,0]
    v_cvt_pk_bf16_f32 v184, v184, v185
    v_cvt_pk_bf16_f32 v185, v186, v187
    v_cvt_pk_bf16_f32 v186, v196, v197
    v_cvt_pk_bf16_f32 v187, v198, v199
    v_exp_f32 v188, v188
    v_exp_f32 v189, v189
    v_exp_f32 v190, v190
    v_exp_f32 v191, v191
    v_exp_f32 v200, v200
    v_exp_f32 v201, v201
    v_exp_f32 v202, v202
    v_exp_f32 v203, v203
    ds_write_b128 v15, v[184:187] offset:3072
    v_mfma_f32_16x16x32_bf16 v[132:135], v[128:131], v[184:187], v[132:135]
    v_pk_fma_f32 v[192:193], v[192:193], v[14:15], v[34:35] op_sel:[0,0,1] op_sel_hi:[1,0,1]
    v_pk_fma_f32 v[194:195], v[194:195], v[14:15], v[34:35] op_sel:[0,0,1] op_sel_hi:[1,0,1]
    v_pk_fma_f32 v[204:205], v[204:205], v[14:15], v[34:35] op_sel:[0,0,1] op_sel_hi:[1,0,1]
    v_pk_fma_f32 v[206:207], v[206:207], v[14:15], v[34:35] op_sel:[0,0,1] op_sel_hi:[1,0,1]
    v_cvt_pk_bf16_f32 v188, v188, v189
    v_cvt_pk_bf16_f32 v189, v190, v191
    v_cvt_pk_bf16_f32 v190, v200, v201
    v_cvt_pk_bf16_f32 v191, v202, v203
    v_exp_f32 v192, v192
    v_exp_f32 v193, v193
    v_exp_f32 v194, v194
    v_exp_f32 v195, v195
    v_exp_f32 v204, v204
    v_exp_f32 v205, v205
    v_exp_f32 v206, v206
    v_exp_f32 v207, v207
    ds_write_b128 v15, v[188:191] offset:4096
    v_mfma_f32_16x16x32_bf16 v[136:139], v[128:131], v[188:191], v[136:139]
    v_lshrrev_b32 v12, 2, v2
    v_lshl_add_u32 v13, v3, 2, v12
    v_and_b32 v36, 7, v13
    v_lshlrev_b32 v13, 8, v13
    v_lshl_add_u32 v13, v36, 5, v13
    v_and_b32 v12, 3, v2
    v_lshl_add_u32 v13, v12, 3, v13
    s_lshl_b32 s51, s45, 6
    s_add_u32 s51, s51, 0
    v_xor_b32 v28, s51, v13
    v_add_u32 v30, 0x10000, v28
    s_lshl_b32 s51, s45, 6
    s_add_u32 s51, s51, 32
    v_xor_b32 v31, s51, v13
    v_add_u32 v32, 0x10000, v31
    s_lshl_b32 s51, s45, 15
    s_lshl_b32 s52, s44, 13
    s_add_u32 s51, s51, s52
    s_add_u32 s51, s51, 0x4c00
    v_lshrrev_b32 v12, 1, v3
    v_lshrrev_b32 v13, 1, v2
    v_and_b32 v13, 3, v13
    v_xor_b32 v12, v12, v13
    v_lshlrev_b32 v12, 4, v12
    v_and_b32 v13, 1, v3
    v_lshl_add_u32 v12, v13, 3, v12
    v_lshl_add_u32 v29, v2, 6, v12
    v_add_u32 v29, s51, v29
    v_cvt_pk_bf16_f32 v192, v192, v193
    v_cvt_pk_bf16_f32 v193, v194, v195
    v_cvt_pk_bf16_f32 v194, v204, v205
    v_cvt_pk_bf16_f32 v195, v206, v207
    ds_write_b128 v15, v[192:195] offset:5120
    s_nop 0
    v_mfma_f32_16x16x32_bf16 v[140:143], v[128:131], v[192:195], v[140:143]
    v_lshrrev_b32 v12, 3, v2
    v_lshlrev_b32 v12, 15, v12
    v_lshl_add_u32 v12, v3, 13, v12
    v_and_b32 v13, 7, v2
    v_lshl_add_u32 v8, v13, 4, v12
    s_lshl_b32 s49, s56, 18
    s_lshl_b32 s51, s40, 7
    s_add_u32 s90, s49, s51
    s_waitcnt vmcnt(6)
    s_waitcnt lgkmcnt(0)
    s_barrier
    ds_read_b128 v[152:155], v37
    ds_read_b128 v[156:159], v37 offset:1024
    ds_read_b128 v[160:163], v37 offset:2048
    ds_read_b64_tr_b16 v[144:145], v28
    ds_read_b64_tr_b16 v[146:147], v28 offset:4096
    ds_read_b64_tr_b16 v[148:149], v31
    ds_read_b64_tr_b16 v[150:151], v31 offset:4096
    ds_read_b128 v[172:175], v37 offset:32768
    ds_read_b128 v[176:179], v37 offset:33792
    ds_read_b128 v[180:183], v37 offset:34816
    ds_read_b64_tr_b16 v[164:165], v28 offset:32768
    ds_read_b64_tr_b16 v[166:167], v28 offset:36864
    ds_read_b64_tr_b16 v[168:169], v31 offset:32768
    ds_read_b64_tr_b16 v[170:171], v31 offset:36864
    ds_read_b128 v[192:195], v38
    ds_read_b128 v[196:199], v38 offset:1024
    ds_read_b128 v[200:203], v38 offset:2048
    ds_read_b64_tr_b16 v[184:185], v30
    ds_read_b64_tr_b16 v[186:187], v30 offset:4096
    ds_read_b64_tr_b16 v[188:189], v32
    ds_read_b64_tr_b16 v[190:191], v32 offset:4096
    s_waitcnt lgkmcnt(14)
    v_mfma_f32_16x16x32_bf16 v[104:107], v[144:147], v[152:155], 0
    ds_read_b128 v[76:79], v38 offset:32768
    ds_read_b128 v[80:83], v38 offset:33792
    v_fma_f32 v208, v208, s48, v33
    v_fma_f32 v209, v209, s48, v33
    v_fma_f32 v210, v210, s48, v33
    v_fma_f32 v211, v211, s48, v33
    v_mfma_f32_16x16x32_bf16 v[108:111], v[144:147], v[156:159], 0
    ds_read_b128 v[84:87], v38 offset:34816
    ds_read_b64_tr_b16 v[204:205], v30 offset:32768
    v_fma_f32 v220, v220, s48, v33
    v_fma_f32 v221, v221, s48, v33
    v_fma_f32 v222, v222, s48, v33
    v_fma_f32 v223, v223, s48, v33
    v_mfma_f32_16x16x32_bf16 v[112:115], v[144:147], v[160:163], 0
    ds_read_b64_tr_b16 v[206:207], v30 offset:36864
    ds_read_b64_tr_b16 v[72:73], v32 offset:32768
    v_exp_f32 v208, v208
    v_exp_f32 v209, v209
    v_exp_f32 v210, v210
    v_exp_f32 v211, v211
    s_add_u32 s49, s57, 0
    s_and_b32 s49, s49, 3
    s_lshl_b32 s49, s49, 16
    s_add_u32 s49, s49, s90
    s_add_u32 s50, s49, 0x1000
    buffer_load_dwordx4 v[16:19], v8, s[60:63], s49 offen
    buffer_load_dwordx4 v[20:23], v8, s[60:63], s49 offen offset:1024
    v_mfma_f32_16x16x32_bf16 v[116:119], v[148:151], v[152:155], 0
    ds_read_b64_tr_b16 v[74:75], v32 offset:36864
    v_exp_f32 v220, v220
    v_exp_f32 v221, v221
    v_exp_f32 v222, v222
    v_exp_f32 v223, v223
    v_mfma_f32_16x16x32_bf16 v[120:123], v[148:151], v[156:159], 0
    v_fma_f32 v212, v212, s48, v34
    v_fma_f32 v213, v213, s48, v34
    v_fma_f32 v214, v214, s48, v34
    v_fma_f32 v215, v215, s48, v34
    v_mfma_f32_16x16x32_bf16 v[124:127], v[148:151], v[160:163], 0
    v_fma_f32 v224, v224, s48, v34
    v_fma_f32 v225, v225, s48, v34
    v_fma_f32 v226, v226, s48, v34
    v_fma_f32 v227, v227, s48, v34
    s_waitcnt lgkmcnt(14)
    v_mfma_f32_16x16x32_bf16 v[104:107], v[164:167], v[172:175], v[104:107]
    ds_read_b128 v[152:155], v37 offset:3072
    ds_read_b128 v[156:159], v37 offset:4096
    v_cvt_pk_bf16_f32 v208, v208, v209
    v_cvt_pk_bf16_f32 v209, v210, v211
    v_cvt_pk_bf16_f32 v210, v220, v221
    v_cvt_pk_bf16_f32 v211, v222, v223
    v_mfma_f32_16x16x32_bf16 v[108:111], v[164:167], v[176:179], v[108:111]
    ds_read_b128 v[160:163], v37 offset:5120
    v_exp_f32 v212, v212
    v_exp_f32 v213, v213
    v_exp_f32 v214, v214
    v_exp_f32 v215, v215
    v_mfma_f32_16x16x32_bf16 v[112:115], v[164:167], v[180:183], v[112:115]
    v_exp_f32 v224, v224
    v_exp_f32 v225, v225
    v_exp_f32 v226, v226
    v_exp_f32 v227, v227
    buffer_load_dwordx4 v[88:91], v8, s[60:63], s49 offen offset:2048
    buffer_load_dwordx4 v[92:95], v8, s[60:63], s49 offen offset:3072
    v_mfma_f32_16x16x32_bf16 v[116:119], v[168:171], v[172:175], v[116:119]
    ds_write_b128 v24, v[208:211]
    v_mfma_f32_16x16x32_bf16 v[132:135], v[128:131], v[208:211], v[132:135]
    v_fma_f32 v216, v216, s48, v35
    v_fma_f32 v217, v217, s48, v35
    v_mfma_f32_16x16x32_bf16 v[120:123], v[168:171], v[176:179], v[120:123]
    v_fma_f32 v218, v218, s48, v35
    v_fma_f32 v219, v219, s48, v35
    v_fma_f32 v228, v228, s48, v35
    v_fma_f32 v229, v229, s48, v35
    v_mfma_f32_16x16x32_bf16 v[124:127], v[168:171], v[180:183], v[124:127]
    v_fma_f32 v230, v230, s48, v35
    v_fma_f32 v231, v231, s48, v35
    v_cvt_pk_bf16_f32 v212, v212, v213
    v_cvt_pk_bf16_f32 v213, v214, v215
    s_waitcnt lgkmcnt(11)
    s_waitcnt vmcnt(6)
    s_waitcnt lgkmcnt(4)
    s_barrier
    v_mfma_f32_16x16x32_bf16 v[104:107], v[184:187], v[192:195], v[104:107]
    ds_read_b64_tr_b16 v[144:145], v28 offset:8192
    ds_read_b64_tr_b16 v[146:147], v28 offset:12288
    v_cvt_pk_bf16_f32 v214, v224, v225
    v_cvt_pk_bf16_f32 v215, v226, v227
    v_exp_f32 v216, v216
    v_exp_f32 v217, v217
    v_mfma_f32_16x16x32_bf16 v[108:111], v[184:187], v[196:199], v[108:111]
    ds_read_b64_tr_b16 v[148:149], v31 offset:8192
    ds_read_b64_tr_b16 v[150:151], v31 offset:12288
    v_exp_f32 v218, v218
    v_exp_f32 v219, v219
    v_exp_f32 v228, v228
    v_exp_f32 v229, v229
    ds_write_b128 v10, v[40:43]
    v_mfma_f32_16x16x32_bf16 v[112:115], v[184:187], v[200:203], v[112:115]
    ds_read_b128 v[172:175], v37 offset:35840
    ds_read_b128 v[176:179], v37 offset:36864
    v_exp_f32 v230, v230
    v_exp_f32 v231, v231
    ds_write_b128 v24, v[212:215] offset:1024
    v_mfma_f32_16x16x32_bf16 v[136:139], v[128:131], v[212:215], v[136:139]
    buffer_load_dwordx4 v[96:99], v8, s[60:63], s50 offen
    v_mfma_f32_16x16x32_bf16 v[116:119], v[188:191], v[192:195], v[116:119]
    ds_read_b128 v[180:183], v37 offset:37888
    ds_read_b64_tr_b16 v[164:165], v28 offset:40960
    v_cvt_pk_bf16_f32 v216, v216, v217
    v_cvt_pk_bf16_f32 v217, v218, v219
    v_cvt_pk_bf16_f32 v218, v228, v229
    v_cvt_pk_bf16_f32 v219, v230, v231
    v_mfma_f32_16x16x32_bf16 v[120:123], v[188:191], v[196:199], v[120:123]
    ds_read_b64_tr_b16 v[166:167], v28 offset:45056
    ds_read_b64_tr_b16 v[168:169], v31 offset:40960
    ds_write_b128 v24, v[216:219] offset:2048
    v_mfma_f32_16x16x32_bf16 v[140:143], v[128:131], v[216:219], v[140:143]
    v_fma_f32 v232, v232, s48, v33
    v_fma_f32 v233, v233, s48, v33
    ds_write_b128 v11, v[44:47] offset:1024
    v_mfma_f32_16x16x32_bf16 v[124:127], v[188:191], v[200:203], v[124:127]
    ds_read_b64_tr_b16 v[170:171], v31 offset:45056
    v_fma_f32 v234, v234, s48, v33
    v_fma_f32 v235, v235, s48, v33
    v_fma_f32 v244, v244, s48, v33
    v_fma_f32 v245, v245, s48, v33
    v_mfma_f32_16x16x32_bf16 v[104:107], v[204:207], v[76:79], v[104:107]
    ds_read_b128 v[192:195], v38 offset:3072
    ds_read_b128 v[196:199], v38 offset:4096
    v_fma_f32 v246, v246, s48, v33
    v_fma_f32 v247, v247, s48, v33
    v_exp_f32 v232, v232
    v_exp_f32 v233, v233
    v_mfma_f32_16x16x32_bf16 v[108:111], v[204:207], v[80:83], v[108:111]
    ds_read_b128 v[200:203], v38 offset:5120
    ds_read_b64_tr_b16 v[184:185], v30 offset:8192
    v_exp_f32 v234, v234
    v_exp_f32 v235, v235
    v_exp_f32 v244, v244
    v_exp_f32 v245, v245
    ds_write_b128 v10, v[48:51] offset:2048
    v_mfma_f32_16x16x32_bf16 v[112:115], v[204:207], v[84:87], v[112:115]
    ds_read_b64_tr_b16 v[186:187], v30 offset:12288
    ds_read_b64_tr_b16 v[188:189], v32 offset:8192
    v_exp_f32 v246, v246
    v_exp_f32 v247, v247
    v_fma_f32 v236, v236, s48, v34
    v_fma_f32 v237, v237, s48, v34
    buffer_load_dwordx4 v[100:103], v8, s[60:63], s50 offen offset:1024
    v_mfma_f32_16x16x32_bf16 v[116:119], v[72:75], v[76:79], v[116:119]
    ds_read_b64_tr_b16 v[190:191], v32 offset:12288
    v_fma_f32 v238, v238, s48, v34
    v_fma_f32 v239, v239, s48, v34
    v_fma_f32 v248, v248, s48, v34
    v_fma_f32 v249, v249, s48, v34
    v_mfma_f32_16x16x32_bf16 v[120:123], v[72:75], v[80:83], v[120:123]
    v_fma_f32 v250, v250, s48, v34
    v_fma_f32 v251, v251, s48, v34
    v_cvt_pk_bf16_f32 v232, v232, v233
    v_cvt_pk_bf16_f32 v233, v234, v235
    ds_write_b128 v11, v[52:55] offset:3072
    v_mfma_f32_16x16x32_bf16 v[124:127], v[72:75], v[84:87], v[124:127]
    v_cvt_pk_bf16_f32 v234, v244, v245
    v_cvt_pk_bf16_f32 v235, v246, v247
    v_exp_f32 v236, v236
    v_exp_f32 v237, v237
    s_waitcnt lgkmcnt(15)
    s_waitcnt lgkmcnt(11)
    v_mfma_f32_16x16x32_bf16 v[104:107], v[144:147], v[152:155], v[104:107]
    ds_read_b128 v[76:79], v38 offset:35840
    ds_read_b128 v[80:83], v38 offset:36864
    v_exp_f32 v238, v238
    v_exp_f32 v239, v239
    v_exp_f32 v248, v248
    v_exp_f32 v249, v249
    v_mfma_f32_16x16x32_bf16 v[108:111], v[144:147], v[156:159], v[108:111]
    ds_read_b128 v[84:87], v38 offset:37888
    ds_read_b64_tr_b16 v[204:205], v30 offset:40960
    v_exp_f32 v250, v250
    v_exp_f32 v251, v251
    ds_write_b128 v15, v[232:235]
    v_mfma_f32_16x16x32_bf16 v[132:135], v[128:131], v[232:235], v[132:135]
    v_mfma_f32_16x16x32_bf16 v[112:115], v[144:147], v[160:163], v[112:115]
    ds_read_b64_tr_b16 v[206:207], v30 offset:45056
    ds_read_b64_tr_b16 v[72:73], v32 offset:40960
    v_fma_f32 v240, v240, s48, v35
    v_fma_f32 v241, v241, s48, v35
    v_fma_f32 v242, v242, s48, v35
    v_fma_f32 v243, v243, s48, v35
    buffer_load_dwordx4 v[208:211], v8, s[60:63], s50 offen offset:2048
    buffer_load_dwordx4 v[212:215], v8, s[60:63], s50 offen offset:3072
    v_mfma_f32_16x16x32_bf16 v[116:119], v[148:151], v[152:155], v[116:119]
    ds_read_b64_tr_b16 v[74:75], v32 offset:45056
    v_fma_f32 v252, v252, s48, v35
    v_fma_f32 v253, v253, s48, v35
    v_fma_f32 v254, v254, s48, v35
    v_fma_f32 v255, v255, s48, v35
    v_mfma_f32_16x16x32_bf16 v[120:123], v[148:151], v[156:159], v[120:123]
    v_cvt_pk_bf16_f32 v236, v236, v237
    v_cvt_pk_bf16_f32 v237, v238, v239
    v_cvt_pk_bf16_f32 v238, v248, v249
    v_cvt_pk_bf16_f32 v239, v250, v251
    v_mfma_f32_16x16x32_bf16 v[124:127], v[148:151], v[160:163], v[124:127]
    v_exp_f32 v240, v240
    v_exp_f32 v241, v241
    v_exp_f32 v242, v242
    v_exp_f32 v243, v243
    s_waitcnt lgkmcnt(15)
    v_mfma_f32_16x16x32_bf16 v[104:107], v[164:167], v[172:175], v[104:107]
    v_exp_f32 v252, v252
    v_exp_f32 v253, v253
    v_exp_f32 v254, v254
    v_exp_f32 v255, v255
    v_mfma_f32_16x16x32_bf16 v[108:111], v[164:167], v[176:179], v[108:111]
    ds_write_b128 v15, v[236:239] offset:1024
    v_mfma_f32_16x16x32_bf16 v[136:139], v[128:131], v[236:239], v[136:139]
    v_cvt_pk_bf16_f32 v240, v240, v241
    v_cvt_pk_bf16_f32 v241, v242, v243
    v_mfma_f32_16x16x32_bf16 v[112:115], v[164:167], v[180:183], v[112:115]
    v_cvt_pk_bf16_f32 v242, v252, v253
    v_cvt_pk_bf16_f32 v243, v254, v255
    ds_write_b128 v15, v[240:243] offset:2048
    s_nop 0
    v_mfma_f32_16x16x32_bf16 v[140:143], v[128:131], v[240:243], v[140:143]
    s_add_u32 s49, s57, 1
    s_and_b32 s49, s49, 3
    s_lshl_b32 s49, s49, 16
    s_add_u32 s49, s49, s90
    s_add_u32 s50, s49, 0x1000
    buffer_load_dwordx4 v[216:219], v8, s[60:63], s49 offen
    buffer_load_dwordx4 v[220:223], v8, s[60:63], s49 offen offset:1024
    v_mfma_f32_16x16x32_bf16 v[116:119], v[168:171], v[172:175], v[116:119]
    ds_write_b32 v15, v132 offset:6144
    ds_write_b32 v15, v136 offset:6148
    ds_write_b32 v15, v140 offset:6152
    v_mfma_f32_16x16x32_bf16 v[120:123], v[168:171], v[176:179], v[120:123]
    v_mfma_f32_16x16x32_bf16 v[124:127], v[168:171], v[180:183], v[124:127]
    s_waitcnt lgkmcnt(14)
    s_waitcnt lgkmcnt(0)
    s_barrier
    v_mfma_f32_16x16x32_bf16 v[104:107], v[184:187], v[192:195], v[104:107]
    ds_read_b128 v[152:155], v39
    ds_read_b128 v[156:159], v39 offset:1024
    ds_read_b128 v[160:163], v39 offset:2048
    v_mfma_f32_16x16x32_bf16 v[108:111], v[184:187], v[196:199], v[108:111]
    ds_read_b64_tr_b16 v[144:145], v28
    ds_read_b64_tr_b16 v[146:147], v28 offset:4096
    ds_read_b64_tr_b16 v[148:149], v31
    ds_write_b128 v10, v[56:59] offset:8192
    v_mfma_f32_16x16x32_bf16 v[112:115], v[184:187], v[200:203], v[112:115]
    ds_read_b64_tr_b16 v[150:151], v31 offset:4096
    ds_read_b128 v[172:175], v39 offset:3072
    buffer_load_dwordx4 v[224:227], v8, s[60:63], s49 offen offset:2048
    v_mfma_f32_16x16x32_bf16 v[116:119], v[188:191], v[192:195], v[116:119]
    ds_read_b128 v[176:179], v39 offset:4096
    ds_read_b128 v[180:183], v39 offset:5120
    v_mfma_f32_16x16x32_bf16 v[120:123], v[188:191], v[196:199], v[120:123]
    ds_read_b64_tr_b16 v[164:165], v28 offset:32768
    ds_read_b64_tr_b16 v[166:167], v28 offset:36864
    ds_write_b128 v11, v[60:63] offset:9216
    v_mfma_f32_16x16x32_bf16 v[124:127], v[188:191], v[200:203], v[124:127]
    ds_read_b64_tr_b16 v[168:169], v31 offset:32768
    ds_read_b64_tr_b16 v[170:171], v31 offset:36864
    v_mfma_f32_16x16x32_bf16 v[104:107], v[204:207], v[76:79], v[104:107]
    ds_read_b128 v[192:195], v39 offset:6144
    ds_read_b128 v[196:199], v39 offset:7168
    v_mfma_f32_16x16x32_bf16 v[108:111], v[204:207], v[80:83], v[108:111]
    ds_read_b128 v[200:203], v39 offset:8192
    ds_read_b64_tr_b16 v[184:185], v30
    ds_write_b128 v10, v[64:67] offset:10240
    v_mfma_f32_16x16x32_bf16 v[112:115], v[204:207], v[84:87], v[112:115]
    ds_read_b64_tr_b16 v[186:187], v30 offset:4096
    ds_read_b64_tr_b16 v[188:189], v32
    buffer_load_dwordx4 v[228:231], v8, s[60:63], s49 offen offset:3072
    v_mfma_f32_16x16x32_bf16 v[116:119], v[72:75], v[76:79], v[116:119]
    ds_read_b64_tr_b16 v[190:191], v32 offset:4096
    ds_read_b128 v[132:135], v37 offset:6144
    v_mfma_f32_16x16x32_bf16 v[120:123], v[72:75], v[80:83], v[120:123]
    ds_read_b128 v[136:139], v37 offset:38912
    ds_read_b128 v[140:143], v38 offset:6144
    ds_write_b128 v11, v[68:71] offset:11264
    v_mfma_f32_16x16x32_bf16 v[124:127], v[72:75], v[84:87], v[124:127]
    ds_read_b128 v[24:27], v38 offset:38912
    s_waitcnt lgkmcnt(15)
    v_mfma_f32_16x16x32_bf16 v[104:107], v[144:147], v[152:155], v[104:107]
    ds_read_b128 v[76:79], v39 offset:9216
    ds_read_b128 v[80:83], v39 offset:10240
    v_mfma_f32_16x16x32_bf16 v[108:111], v[144:147], v[156:159], v[108:111]
    ds_read_b128 v[84:87], v39 offset:11264
    ds_read_b64_tr_b16 v[204:205], v30 offset:32768
    v_mfma_f32_16x16x32_bf16 v[112:115], v[144:147], v[160:163], v[112:115]
    ds_read_b64_tr_b16 v[206:207], v30 offset:36864
    ds_read_b64_tr_b16 v[72:73], v32 offset:32768
    buffer_load_dwordx4 v[232:235], v8, s[60:63], s50 offen
    buffer_load_dwordx4 v[236:239], v8, s[60:63], s50 offen offset:1024
    v_mfma_f32_16x16x32_bf16 v[116:119], v[148:151], v[152:155], v[116:119]
    ds_read_b64_tr_b16 v[74:75], v32 offset:36864
    v_mfma_f32_16x16x32_bf16 v[120:123], v[148:151], v[156:159], v[120:123]
    v_mfma_f32_16x16x32_bf16 v[124:127], v[148:151], v[160:163], v[124:127]
    s_waitcnt lgkmcnt(15)
    v_mfma_f32_16x16x32_bf16 v[104:107], v[164:167], v[172:175], v[104:107]
    ds_read_b128 v[152:155], v37
    ds_read_b128 v[156:159], v37 offset:1024
    v_mfma_f32_16x16x32_bf16 v[108:111], v[164:167], v[176:179], v[108:111]
    ds_read_b128 v[160:163], v37 offset:2048
    v_mfma_f32_16x16x32_bf16 v[112:115], v[164:167], v[180:183], v[112:115]
    buffer_load_dwordx4 v[240:243], v8, s[60:63], s50 offen offset:2048
    buffer_load_dwordx4 v[244:247], v8, s[60:63], s50 offen offset:3072
    s_add_u32 s49, s57, 2
    s_and_b32 s49, s49, 3
    s_lshl_b32 s49, s49, 16
    s_add_u32 s49, s49, s90
    s_add_u32 s50, s49, 0x1000
    buffer_load_dwordx4 v[248:251], v8, s[60:63], s49 offen
    v_mfma_f32_16x16x32_bf16 v[116:119], v[168:171], v[172:175], v[116:119]
    v_mfma_f32_16x16x32_bf16 v[120:123], v[168:171], v[176:179], v[120:123]
    v_mfma_f32_16x16x32_bf16 v[124:127], v[168:171], v[180:183], v[124:127]
    s_waitcnt lgkmcnt(10)
    v_add_f32 v33, v132, v136
    v_add_f32 v36, v140, v24
    v_add_f32 v33, v33, v36
    v_rcp_f32 v33, v33
    v_add_f32 v34, v133, v137
    v_add_f32 v36, v141, v25
    v_add_f32 v34, v34, v36
    v_rcp_f32 v34, v34
    v_add_f32 v35, v134, v138
    v_add_f32 v36, v142, v26
    v_add_f32 v35, v35, v36
    v_rcp_f32 v35, v35
    s_barrier
    v_mfma_f32_16x16x32_bf16 v[104:107], v[184:187], v[192:195], v[104:107]
    ds_read_b64_tr_b16 v[144:145], v28 offset:8192
    ds_read_b64_tr_b16 v[146:147], v28 offset:12288
    v_mfma_f32_16x16x32_bf16 v[108:111], v[184:187], v[196:199], v[108:111]
    ds_read_b64_tr_b16 v[148:149], v31 offset:8192
    ds_read_b64_tr_b16 v[150:151], v31 offset:12288
    v_mfma_f32_16x16x32_bf16 v[112:115], v[184:187], v[200:203], v[112:115]
    ds_read_b128 v[172:175], v37 offset:32768
    ds_read_b128 v[176:179], v37 offset:33792
    buffer_load_dwordx4 v[252:255], v8, s[60:63], s49 offen offset:1024
    buffer_load_dwordx4 v[40:43], v8, s[60:63], s49 offen offset:2048
    v_mfma_f32_16x16x32_bf16 v[116:119], v[188:191], v[192:195], v[116:119]
    ds_read_b128 v[180:183], v37 offset:34816
    ds_read_b64_tr_b16 v[164:165], v28 offset:40960
    v_mfma_f32_16x16x32_bf16 v[120:123], v[188:191], v[196:199], v[120:123]
    ds_read_b64_tr_b16 v[166:167], v28 offset:45056
    ds_read_b64_tr_b16 v[168:169], v31 offset:40960
    v_mfma_f32_16x16x32_bf16 v[124:127], v[188:191], v[200:203], v[124:127]
    ds_read_b64_tr_b16 v[170:171], v31 offset:45056
    s_waitcnt lgkmcnt(14)
    v_mfma_f32_16x16x32_bf16 v[104:107], v[204:207], v[76:79], v[104:107]
    ds_read_b128 v[192:195], v38
    ds_read_b128 v[196:199], v38 offset:1024
    v_mfma_f32_16x16x32_bf16 v[108:111], v[204:207], v[80:83], v[108:111]
    ds_read_b128 v[200:203], v38 offset:2048
    ds_read_b64_tr_b16 v[184:185], v30 offset:8192
    v_mfma_f32_16x16x32_bf16 v[112:115], v[204:207], v[84:87], v[112:115]
    ds_read_b64_tr_b16 v[186:187], v30 offset:12288
    ds_read_b64_tr_b16 v[188:189], v32 offset:8192
    buffer_load_dwordx4 v[44:47], v8, s[60:63], s49 offen offset:3072
    buffer_load_dwordx4 v[48:51], v8, s[60:63], s50 offen
    v_mfma_f32_16x16x32_bf16 v[116:119], v[72:75], v[76:79], v[116:119]
    ds_read_b64_tr_b16 v[190:191], v32 offset:12288
    v_mfma_f32_16x16x32_bf16 v[120:123], v[72:75], v[80:83], v[120:123]
    v_mfma_f32_16x16x32_bf16 v[124:127], v[72:75], v[84:87], v[124:127]
    s_waitcnt lgkmcnt(14)
    v_mfma_f32_16x16x32_bf16 v[104:107], v[144:147], v[152:155], v[104:107]
    ds_read_b128 v[76:79], v38 offset:32768
    ds_read_b128 v[80:83], v38 offset:33792
    v_mfma_f32_16x16x32_bf16 v[108:111], v[144:147], v[156:159], v[108:111]
    ds_read_b128 v[84:87], v38 offset:34816
    ds_read_b64_tr_b16 v[204:205], v30 offset:40960
    v_mfma_f32_16x16x32_bf16 v[112:115], v[144:147], v[160:163], v[112:115]
    ds_read_b64_tr_b16 v[206:207], v30 offset:45056
    ds_read_b64_tr_b16 v[72:73], v32 offset:40960
    buffer_load_dwordx4 v[52:55], v8, s[60:63], s50 offen offset:1024
    v_mfma_f32_16x16x32_bf16 v[116:119], v[148:151], v[152:155], v[116:119]
    ds_read_b64_tr_b16 v[74:75], v32 offset:45056
    v_mfma_f32_16x16x32_bf16 v[120:123], v[148:151], v[156:159], v[120:123]
    v_mfma_f32_16x16x32_bf16 v[124:127], v[148:151], v[160:163], v[124:127]
    s_waitcnt lgkmcnt(14)
    v_mfma_f32_16x16x32_bf16 v[104:107], v[164:167], v[172:175], v[104:107]
    v_mfma_f32_16x16x32_bf16 v[108:111], v[164:167], v[176:179], v[108:111]
    v_mfma_f32_16x16x32_bf16 v[112:115], v[164:167], v[180:183], v[112:115]
    buffer_load_dwordx4 v[56:59], v8, s[60:63], s50 offen offset:2048
    v_mfma_f32_16x16x32_bf16 v[116:119], v[168:171], v[172:175], v[116:119]
    v_mfma_f32_16x16x32_bf16 v[120:123], v[168:171], v[176:179], v[120:123]
    v_mfma_f32_16x16x32_bf16 v[124:127], v[168:171], v[180:183], v[124:127]
    s_waitcnt lgkmcnt(7)
    v_mfma_f32_16x16x32_bf16 v[104:107], v[184:187], v[192:195], v[104:107]
    v_mfma_f32_16x16x32_bf16 v[108:111], v[184:187], v[196:199], v[108:111]
    v_mfma_f32_16x16x32_bf16 v[112:115], v[184:187], v[200:203], v[112:115]
    buffer_load_dwordx4 v[60:63], v8, s[60:63], s50 offen offset:3072
    v_mfma_f32_16x16x32_bf16 v[116:119], v[188:191], v[192:195], v[116:119]
    v_mfma_f32_16x16x32_bf16 v[120:123], v[188:191], v[196:199], v[120:123]
    v_mfma_f32_16x16x32_bf16 v[124:127], v[188:191], v[200:203], v[124:127]
    s_waitcnt lgkmcnt(0)
    v_mfma_f32_16x16x32_bf16 v[104:107], v[204:207], v[76:79], v[104:107]
    v_mfma_f32_16x16x32_bf16 v[108:111], v[204:207], v[80:83], v[108:111]
    v_mfma_f32_16x16x32_bf16 v[112:115], v[204:207], v[84:87], v[112:115]
    s_add_u32 s49, s57, 3
    s_and_b32 s49, s49, 3
    s_lshl_b32 s49, s49, 16
    s_add_u32 s49, s49, s90
    s_add_u32 s50, s49, 0x1000
    buffer_load_dwordx4 v[64:67], v8, s[60:63], s49 offen
    v_mfma_f32_16x16x32_bf16 v[116:119], v[72:75], v[76:79], v[116:119]
    v_mfma_f32_16x16x32_bf16 v[120:123], v[72:75], v[80:83], v[120:123]
    v_mfma_f32_16x16x32_bf16 v[124:127], v[72:75], v[84:87], v[124:127]
    v_xor_b32 v13, 32, v29
    v_mul_f32 v104, v104, v33
    v_mul_f32 v105, v105, v33
    v_mul_f32 v106, v106, v33
    v_mul_f32 v107, v107, v33
    v_cvt_pk_bf16_f32 v104, v104, v105
    v_cvt_pk_bf16_f32 v105, v106, v107
    ds_write_b64 v29, v[104:105]
    v_mul_f32 v116, v116, v33
    v_mul_f32 v117, v117, v33
    v_mul_f32 v118, v118, v33
    v_mul_f32 v119, v119, v33
    v_cvt_pk_bf16_f32 v116, v116, v117
    v_cvt_pk_bf16_f32 v117, v118, v119
    ds_write_b64 v13, v[116:117]
    v_mul_f32 v108, v108, v34
    v_mul_f32 v109, v109, v34
    v_mul_f32 v110, v110, v34
    v_mul_f32 v111, v111, v34
    v_cvt_pk_bf16_f32 v108, v108, v109
    v_cvt_pk_bf16_f32 v109, v110, v111
    ds_write_b64 v29, v[108:109] offset:1024
    v_mul_f32 v120, v120, v34
    v_mul_f32 v121, v121, v34
    v_mul_f32 v122, v122, v34
    v_mul_f32 v123, v123, v34
    v_cvt_pk_bf16_f32 v120, v120, v121
    v_cvt_pk_bf16_f32 v121, v122, v123
    ds_write_b64 v13, v[120:121] offset:1024
    v_mul_f32 v112, v112, v35
    v_mul_f32 v113, v113, v35
    v_mul_f32 v114, v114, v35
    v_mul_f32 v115, v115, v35
    v_cvt_pk_bf16_f32 v112, v112, v113
    v_cvt_pk_bf16_f32 v113, v114, v115
    ds_write_b64 v29, v[112:113] offset:2048
    v_mul_f32 v124, v124, v35
    v_mul_f32 v125, v125, v35
    v_mul_f32 v126, v126, v35
    v_mul_f32 v127, v127, v35
    v_cvt_pk_bf16_f32 v124, v124, v125
    v_cvt_pk_bf16_f32 v125, v126, v127
    ds_write_b64 v13, v[124:125] offset:2048
    v_lshrrev_b32 v13, 1, v2
    v_and_b32 v13, 3, v13
    v_xor_b32 v12, v3, v13
    v_lshlrev_b32 v12, 4, v12
    v_lshl_add_u32 v12, v2, 6, v12
    s_waitcnt vmcnt(17)
    v_cndmask_b32_dpp v14, v18, v16, vcc row_ror:8 row_mask:0xf bank_mask:0xf
    v_cndmask_b32_dpp v30, v22, v20, vcc row_ror:8 row_mask:0xf bank_mask:0xf
    v_perm_b32 v128, v30, v14, s46
    v_perm_b32 v132, v30, v14, s47
    v_cndmask_b32_dpp v31, v90, v88, vcc row_ror:8 row_mask:0xf bank_mask:0xf
    v_cndmask_b32_dpp v32, v94, v92, vcc row_ror:8 row_mask:0xf bank_mask:0xf
    v_perm_b32 v129, v32, v31, s46
    v_perm_b32 v133, v32, v31, s47
    v_cndmask_b32_dpp v14, v98, v96, vcc row_ror:8 row_mask:0xf bank_mask:0xf
    v_cndmask_b32_dpp v30, v102, v100, vcc row_ror:8 row_mask:0xf bank_mask:0xf
    v_perm_b32 v130, v30, v14, s46
    v_perm_b32 v134, v30, v14, s47
    v_cndmask_b32_dpp v31, v210, v208, vcc row_ror:8 row_mask:0xf bank_mask:0xf
    v_cndmask_b32_dpp v32, v214, v212, vcc row_ror:8 row_mask:0xf bank_mask:0xf
    v_perm_b32 v131, v32, v31, s46
    v_perm_b32 v135, v32, v31, s47
    v_cndmask_b32_dpp v14, v19, v17, vcc row_ror:8 row_mask:0xf bank_mask:0xf
    v_cndmask_b32_dpp v30, v23, v21, vcc row_ror:8 row_mask:0xf bank_mask:0xf
    v_perm_b32 v136, v30, v14, s46
    v_perm_b32 v140, v30, v14, s47
    v_cndmask_b32_dpp v31, v91, v89, vcc row_ror:8 row_mask:0xf bank_mask:0xf
    v_cndmask_b32_dpp v32, v95, v93, vcc row_ror:8 row_mask:0xf bank_mask:0xf
    v_perm_b32 v137, v32, v31, s46
    v_perm_b32 v141, v32, v31, s47
    v_cndmask_b32_dpp v14, v99, v97, vcc row_ror:8 row_mask:0xf bank_mask:0xf
    v_cndmask_b32_dpp v30, v103, v101, vcc row_ror:8 row_mask:0xf bank_mask:0xf
    v_perm_b32 v138, v30, v14, s46
    v_perm_b32 v142, v30, v14, s47
    v_cndmask_b32_dpp v31, v211, v209, vcc row_ror:8 row_mask:0xf bank_mask:0xf
    v_cndmask_b32_dpp v32, v215, v213, vcc row_ror:8 row_mask:0xf bank_mask:0xf
    v_perm_b32 v139, v32, v31, s46
    v_perm_b32 v143, v32, v31, s47
    s_waitcnt lgkmcnt(0)
    s_barrier
    v_add_u32 v10, s96, v12
    ds_read_b128 v[104:107], v10
    ds_read_b128 v[108:111], v10 offset:1024
    ds_read_b128 v[112:115], v10 offset:2048
    ds_read_b128 v[116:119], v10 offset:32768
    ds_read_b128 v[120:123], v10 offset:33792
    ds_read_b128 v[124:127], v10 offset:34816
    buffer_load_dwordx4 v[68:71], v8, s[60:63], s49 offen offset:1024
    buffer_load_dwordx4 v[72:75], v8, s[60:63], s49 offen offset:2048
    buffer_load_dwordx4 v[76:79], v8, s[60:63], s49 offen offset:3072
    buffer_load_dwordx4 v[80:83], v8, s[60:63], s50 offen
    buffer_load_dwordx4 v[84:87], v8, s[60:63], s50 offen offset:1024
    buffer_load_dwordx4 v[200:203], v8, s[60:63], s50 offen offset:2048
    buffer_load_dwordx4 v[204:207], v8, s[60:63], s50 offen offset:3072
    s_waitcnt lgkmcnt(3)
    v_mfma_f32_16x16x32_bf16 v[144:147], v[128:131], v[104:107], 0
    v_mov_b32_dpp v18, v16 row_ror:8 row_mask:0xf bank_mask:0x3
    v_mov_b32_dpp v22, v20 row_ror:8 row_mask:0xf bank_mask:0x3
    v_perm_b32 v192, v22, v18, s46
    v_mfma_f32_16x16x32_bf16 v[148:151], v[128:131], v[108:111], 0
    v_perm_b32 v196, v22, v18, s47
    v_mov_b32_dpp v90, v88 row_ror:8 row_mask:0xf bank_mask:0x3
    v_mov_b32_dpp v94, v92 row_ror:8 row_mask:0xf bank_mask:0x3
    v_mfma_f32_16x16x32_bf16 v[152:155], v[128:131], v[112:115], 0
    v_perm_b32 v193, v94, v90, s46
    v_perm_b32 v197, v94, v90, s47
    v_mov_b32_dpp v98, v96 row_ror:8 row_mask:0xf bank_mask:0x3
    v_mfma_f32_16x16x32_bf16 v[156:159], v[132:135], v[104:107], 0
    v_mov_b32_dpp v102, v100 row_ror:8 row_mask:0xf bank_mask:0x3
    v_perm_b32 v194, v102, v98, s46
    v_perm_b32 v198, v102, v98, s47
    v_mfma_f32_16x16x32_bf16 v[160:163], v[132:135], v[108:111], 0
    v_mov_b32_dpp v210, v208 row_ror:8 row_mask:0xf bank_mask:0x3
    v_mov_b32_dpp v214, v212 row_ror:8 row_mask:0xf bank_mask:0x3
    v_perm_b32 v195, v214, v210, s46
    v_mfma_f32_16x16x32_bf16 v[164:167], v[132:135], v[112:115], 0
    v_perm_b32 v199, v214, v210, s47
    v_mov_b32_dpp v19, v17 row_ror:8 row_mask:0xf bank_mask:0x3
    v_mov_b32_dpp v23, v21 row_ror:8 row_mask:0xf bank_mask:0x3
    v_mfma_f32_16x16x32_bf16 v[168:171], v[136:139], v[104:107], 0
    v_perm_b32 v4, v23, v19, s46
    v_perm_b32 v36, v23, v19, s47
    v_mov_b32_dpp v91, v89 row_ror:8 row_mask:0xf bank_mask:0x3
    v_mfma_f32_16x16x32_bf16 v[172:175], v[136:139], v[108:111], 0
    v_mov_b32_dpp v95, v93 row_ror:8 row_mask:0xf bank_mask:0x3
    v_perm_b32 v5, v95, v91, s46
    v_perm_b32 v37, v95, v91, s47
    v_mfma_f32_16x16x32_bf16 v[176:179], v[136:139], v[112:115], 0
    v_mov_b32_dpp v99, v97 row_ror:8 row_mask:0xf bank_mask:0x3
    v_mov_b32_dpp v103, v101 row_ror:8 row_mask:0xf bank_mask:0x3
    v_perm_b32 v6, v103, v99, s46
    v_mfma_f32_16x16x32_bf16 v[180:183], v[140:143], v[104:107], 0
    v_perm_b32 v38, v103, v99, s47
    v_mov_b32_dpp v211, v209 row_ror:8 row_mask:0xf bank_mask:0x3
    v_mov_b32_dpp v215, v213 row_ror:8 row_mask:0xf bank_mask:0x3
    v_mfma_f32_16x16x32_bf16 v[184:187], v[140:143], v[108:111], 0
    v_perm_b32 v7, v215, v211, s46
    v_perm_b32 v39, v215, v211, s47
    v_mfma_f32_16x16x32_bf16 v[188:191], v[140:143], v[112:115], 0
    v_add_u32 v11, s97, v12
    ds_read_b128 v[104:107], v11
    ds_read_b128 v[108:111], v11 offset:1024
    ds_read_b128 v[112:115], v11 offset:2048
    s_waitcnt lgkmcnt(3)
    v_mfma_f32_16x16x32_bf16 v[144:147], v[192:195], v[116:119], v[144:147]
    s_waitcnt vmcnt(16)
    v_cndmask_b32_dpp v14, v218, v216, vcc row_ror:8 row_mask:0xf bank_mask:0xf
    v_cndmask_b32_dpp v30, v222, v220, vcc row_ror:8 row_mask:0xf bank_mask:0xf
    v_perm_b32 v128, v30, v14, s46
    v_mfma_f32_16x16x32_bf16 v[148:151], v[192:195], v[120:123], v[148:151]
    v_perm_b32 v132, v30, v14, s47
    v_cndmask_b32_dpp v31, v226, v224, vcc row_ror:8 row_mask:0xf bank_mask:0xf
    v_cndmask_b32_dpp v32, v230, v228, vcc row_ror:8 row_mask:0xf bank_mask:0xf
    v_mfma_f32_16x16x32_bf16 v[152:155], v[192:195], v[124:127], v[152:155]
    v_perm_b32 v129, v32, v31, s46
    v_perm_b32 v133, v32, v31, s47
    v_cndmask_b32_dpp v14, v234, v232, vcc row_ror:8 row_mask:0xf bank_mask:0xf
    v_mfma_f32_16x16x32_bf16 v[156:159], v[196:199], v[116:119], v[156:159]
    v_cndmask_b32_dpp v30, v238, v236, vcc row_ror:8 row_mask:0xf bank_mask:0xf
    v_perm_b32 v130, v30, v14, s46
    v_perm_b32 v134, v30, v14, s47
    v_mfma_f32_16x16x32_bf16 v[160:163], v[196:199], v[120:123], v[160:163]
    v_cndmask_b32_dpp v31, v242, v240, vcc row_ror:8 row_mask:0xf bank_mask:0xf
    v_cndmask_b32_dpp v32, v246, v244, vcc row_ror:8 row_mask:0xf bank_mask:0xf
    v_perm_b32 v131, v32, v31, s46
    v_mfma_f32_16x16x32_bf16 v[164:167], v[196:199], v[124:127], v[164:167]
    v_perm_b32 v135, v32, v31, s47
    v_cndmask_b32_dpp v14, v219, v217, vcc row_ror:8 row_mask:0xf bank_mask:0xf
    v_cndmask_b32_dpp v30, v223, v221, vcc row_ror:8 row_mask:0xf bank_mask:0xf
    v_mfma_f32_16x16x32_bf16 v[168:171], v[4:7], v[116:119], v[168:171]
    v_perm_b32 v136, v30, v14, s46
    v_perm_b32 v140, v30, v14, s47
    v_cndmask_b32_dpp v31, v227, v225, vcc row_ror:8 row_mask:0xf bank_mask:0xf
    v_mfma_f32_16x16x32_bf16 v[172:175], v[4:7], v[120:123], v[172:175]
    v_cndmask_b32_dpp v32, v231, v229, vcc row_ror:8 row_mask:0xf bank_mask:0xf
    v_perm_b32 v137, v32, v31, s46
    v_perm_b32 v141, v32, v31, s47
    v_mfma_f32_16x16x32_bf16 v[176:179], v[4:7], v[124:127], v[176:179]
    v_cndmask_b32_dpp v14, v235, v233, vcc row_ror:8 row_mask:0xf bank_mask:0xf
    v_cndmask_b32_dpp v30, v239, v237, vcc row_ror:8 row_mask:0xf bank_mask:0xf
    v_perm_b32 v138, v30, v14, s46
    v_mfma_f32_16x16x32_bf16 v[180:183], v[36:39], v[116:119], v[180:183]
    v_perm_b32 v142, v30, v14, s47
    v_cndmask_b32_dpp v31, v243, v241, vcc row_ror:8 row_mask:0xf bank_mask:0xf
    v_cndmask_b32_dpp v32, v247, v245, vcc row_ror:8 row_mask:0xf bank_mask:0xf
    v_mfma_f32_16x16x32_bf16 v[184:187], v[36:39], v[120:123], v[184:187]
    v_perm_b32 v139, v32, v31, s46
    v_perm_b32 v143, v32, v31, s47
    v_mfma_f32_16x16x32_bf16 v[188:191], v[36:39], v[124:127], v[188:191]
    ds_read_b128 v[116:119], v11 offset:32768
    ds_read_b128 v[120:123], v11 offset:33792
    ds_read_b128 v[124:127], v11 offset:34816
    s_waitcnt lgkmcnt(3)
    v_mfma_f32_16x16x32_bf16 v[144:147], v[128:131], v[104:107], v[144:147]
    v_mov_b32_dpp v218, v216 row_ror:8 row_mask:0xf bank_mask:0x3
    v_mov_b32_dpp v222, v220 row_ror:8 row_mask:0xf bank_mask:0x3
    v_perm_b32 v192, v222, v218, s46
    v_mfma_f32_16x16x32_bf16 v[148:151], v[128:131], v[108:111], v[148:151]
    v_perm_b32 v196, v222, v218, s47
    v_mov_b32_dpp v226, v224 row_ror:8 row_mask:0xf bank_mask:0x3
    v_mov_b32_dpp v230, v228 row_ror:8 row_mask:0xf bank_mask:0x3
    v_mfma_f32_16x16x32_bf16 v[152:155], v[128:131], v[112:115], v[152:155]
    v_perm_b32 v193, v230, v226, s46
    v_perm_b32 v197, v230, v226, s47
    v_mov_b32_dpp v234, v232 row_ror:8 row_mask:0xf bank_mask:0x3
    v_mfma_f32_16x16x32_bf16 v[156:159], v[132:135], v[104:107], v[156:159]
    v_mov_b32_dpp v238, v236 row_ror:8 row_mask:0xf bank_mask:0x3
    v_perm_b32 v194, v238, v234, s46
    v_perm_b32 v198, v238, v234, s47
    v_mfma_f32_16x16x32_bf16 v[160:163], v[132:135], v[108:111], v[160:163]
    v_mov_b32_dpp v242, v240 row_ror:8 row_mask:0xf bank_mask:0x3
    v_mov_b32_dpp v246, v244 row_ror:8 row_mask:0xf bank_mask:0x3
    v_perm_b32 v195, v246, v242, s46
    v_mfma_f32_16x16x32_bf16 v[164:167], v[132:135], v[112:115], v[164:167]
    v_perm_b32 v199, v246, v242, s47
    v_mov_b32_dpp v219, v217 row_ror:8 row_mask:0xf bank_mask:0x3
    v_mov_b32_dpp v223, v221 row_ror:8 row_mask:0xf bank_mask:0x3
    v_mfma_f32_16x16x32_bf16 v[168:171], v[136:139], v[104:107], v[168:171]
    v_perm_b32 v4, v223, v219, s46
    v_perm_b32 v36, v223, v219, s47
    v_mov_b32_dpp v227, v225 row_ror:8 row_mask:0xf bank_mask:0x3
    v_mfma_f32_16x16x32_bf16 v[172:175], v[136:139], v[108:111], v[172:175]
    v_mov_b32_dpp v231, v229 row_ror:8 row_mask:0xf bank_mask:0x3
    v_perm_b32 v5, v231, v227, s46
    v_perm_b32 v37, v231, v227, s47
    v_mfma_f32_16x16x32_bf16 v[176:179], v[136:139], v[112:115], v[176:179]
    v_mov_b32_dpp v235, v233 row_ror:8 row_mask:0xf bank_mask:0x3
    v_mov_b32_dpp v239, v237 row_ror:8 row_mask:0xf bank_mask:0x3
    v_perm_b32 v6, v239, v235, s46
    v_mfma_f32_16x16x32_bf16 v[180:183], v[140:143], v[104:107], v[180:183]
    v_perm_b32 v38, v239, v235, s47
    v_mov_b32_dpp v243, v241 row_ror:8 row_mask:0xf bank_mask:0x3
    v_mov_b32_dpp v247, v245 row_ror:8 row_mask:0xf bank_mask:0x3
    v_mfma_f32_16x16x32_bf16 v[184:187], v[140:143], v[108:111], v[184:187]
    v_perm_b32 v7, v247, v243, s46
    v_perm_b32 v39, v247, v243, s47
    v_mfma_f32_16x16x32_bf16 v[188:191], v[140:143], v[112:115], v[188:191]
    v_add_u32 v10, s98, v12
    ds_read_b128 v[104:107], v10
    ds_read_b128 v[108:111], v10 offset:1024
    ds_read_b128 v[112:115], v10 offset:2048
    s_waitcnt lgkmcnt(3)
    v_mfma_f32_16x16x32_bf16 v[144:147], v[192:195], v[116:119], v[144:147]
    s_waitcnt vmcnt(8)
    v_cndmask_b32_dpp v14, v250, v248, vcc row_ror:8 row_mask:0xf bank_mask:0xf
    v_cndmask_b32_dpp v30, v254, v252, vcc row_ror:8 row_mask:0xf bank_mask:0xf
    v_perm_b32 v128, v30, v14, s46
    v_mfma_f32_16x16x32_bf16 v[148:151], v[192:195], v[120:123], v[148:151]
    v_perm_b32 v132, v30, v14, s47
    v_cndmask_b32_dpp v31, v42, v40, vcc row_ror:8 row_mask:0xf bank_mask:0xf
    v_cndmask_b32_dpp v32, v46, v44, vcc row_ror:8 row_mask:0xf bank_mask:0xf
    v_mfma_f32_16x16x32_bf16 v[152:155], v[192:195], v[124:127], v[152:155]
    v_perm_b32 v129, v32, v31, s46
    v_perm_b32 v133, v32, v31, s47
    v_cndmask_b32_dpp v14, v50, v48, vcc row_ror:8 row_mask:0xf bank_mask:0xf
    v_mfma_f32_16x16x32_bf16 v[156:159], v[196:199], v[116:119], v[156:159]
    v_cndmask_b32_dpp v30, v54, v52, vcc row_ror:8 row_mask:0xf bank_mask:0xf
    v_perm_b32 v130, v30, v14, s46
    v_perm_b32 v134, v30, v14, s47
    v_mfma_f32_16x16x32_bf16 v[160:163], v[196:199], v[120:123], v[160:163]
    v_cndmask_b32_dpp v31, v58, v56, vcc row_ror:8 row_mask:0xf bank_mask:0xf
    v_cndmask_b32_dpp v32, v62, v60, vcc row_ror:8 row_mask:0xf bank_mask:0xf
    v_perm_b32 v131, v32, v31, s46
    v_mfma_f32_16x16x32_bf16 v[164:167], v[196:199], v[124:127], v[164:167]
    v_perm_b32 v135, v32, v31, s47
    v_cndmask_b32_dpp v14, v251, v249, vcc row_ror:8 row_mask:0xf bank_mask:0xf
    v_cndmask_b32_dpp v30, v255, v253, vcc row_ror:8 row_mask:0xf bank_mask:0xf
    v_mfma_f32_16x16x32_bf16 v[168:171], v[4:7], v[116:119], v[168:171]
    v_perm_b32 v136, v30, v14, s46
    v_perm_b32 v140, v30, v14, s47
    v_cndmask_b32_dpp v31, v43, v41, vcc row_ror:8 row_mask:0xf bank_mask:0xf
    v_mfma_f32_16x16x32_bf16 v[172:175], v[4:7], v[120:123], v[172:175]
    v_cndmask_b32_dpp v32, v47, v45, vcc row_ror:8 row_mask:0xf bank_mask:0xf
    v_perm_b32 v137, v32, v31, s46
    v_perm_b32 v141, v32, v31, s47
    v_mfma_f32_16x16x32_bf16 v[176:179], v[4:7], v[124:127], v[176:179]
    v_cndmask_b32_dpp v14, v51, v49, vcc row_ror:8 row_mask:0xf bank_mask:0xf
    v_cndmask_b32_dpp v30, v55, v53, vcc row_ror:8 row_mask:0xf bank_mask:0xf
    v_perm_b32 v138, v30, v14, s46
    v_mfma_f32_16x16x32_bf16 v[180:183], v[36:39], v[116:119], v[180:183]
    v_perm_b32 v142, v30, v14, s47
    v_cndmask_b32_dpp v31, v59, v57, vcc row_ror:8 row_mask:0xf bank_mask:0xf
    v_cndmask_b32_dpp v32, v63, v61, vcc row_ror:8 row_mask:0xf bank_mask:0xf
    v_mfma_f32_16x16x32_bf16 v[184:187], v[36:39], v[120:123], v[184:187]
    v_perm_b32 v139, v32, v31, s46
    v_perm_b32 v143, v32, v31, s47
    v_mfma_f32_16x16x32_bf16 v[188:191], v[36:39], v[124:127], v[188:191]
    ds_read_b128 v[116:119], v10 offset:32768
    ds_read_b128 v[120:123], v10 offset:33792
    ds_read_b128 v[124:127], v10 offset:34816
    s_waitcnt lgkmcnt(3)
    v_mfma_f32_16x16x32_bf16 v[144:147], v[128:131], v[104:107], v[144:147]
    v_mov_b32_dpp v250, v248 row_ror:8 row_mask:0xf bank_mask:0x3
    v_mov_b32_dpp v254, v252 row_ror:8 row_mask:0xf bank_mask:0x3
    v_perm_b32 v192, v254, v250, s46
    v_mfma_f32_16x16x32_bf16 v[148:151], v[128:131], v[108:111], v[148:151]
    v_perm_b32 v196, v254, v250, s47
    v_mov_b32_dpp v42, v40 row_ror:8 row_mask:0xf bank_mask:0x3
    v_mov_b32_dpp v46, v44 row_ror:8 row_mask:0xf bank_mask:0x3
    v_mfma_f32_16x16x32_bf16 v[152:155], v[128:131], v[112:115], v[152:155]
    v_perm_b32 v193, v46, v42, s46
    v_perm_b32 v197, v46, v42, s47
    v_mov_b32_dpp v50, v48 row_ror:8 row_mask:0xf bank_mask:0x3
    v_mfma_f32_16x16x32_bf16 v[156:159], v[132:135], v[104:107], v[156:159]
    v_mov_b32_dpp v54, v52 row_ror:8 row_mask:0xf bank_mask:0x3
    v_perm_b32 v194, v54, v50, s46
    v_perm_b32 v198, v54, v50, s47
    v_mfma_f32_16x16x32_bf16 v[160:163], v[132:135], v[108:111], v[160:163]
    v_mov_b32_dpp v58, v56 row_ror:8 row_mask:0xf bank_mask:0x3
    v_mov_b32_dpp v62, v60 row_ror:8 row_mask:0xf bank_mask:0x3
    v_perm_b32 v195, v62, v58, s46
    v_mfma_f32_16x16x32_bf16 v[164:167], v[132:135], v[112:115], v[164:167]
    v_perm_b32 v199, v62, v58, s47
    v_mov_b32_dpp v251, v249 row_ror:8 row_mask:0xf bank_mask:0x3
    v_mov_b32_dpp v255, v253 row_ror:8 row_mask:0xf bank_mask:0x3
    v_mfma_f32_16x16x32_bf16 v[168:171], v[136:139], v[104:107], v[168:171]
    v_perm_b32 v4, v255, v251, s46
    v_perm_b32 v36, v255, v251, s47
    v_mov_b32_dpp v43, v41 row_ror:8 row_mask:0xf bank_mask:0x3
    v_mfma_f32_16x16x32_bf16 v[172:175], v[136:139], v[108:111], v[172:175]
    v_mov_b32_dpp v47, v45 row_ror:8 row_mask:0xf bank_mask:0x3
    v_perm_b32 v5, v47, v43, s46
    v_perm_b32 v37, v47, v43, s47
    v_mfma_f32_16x16x32_bf16 v[176:179], v[136:139], v[112:115], v[176:179]
    v_mov_b32_dpp v51, v49 row_ror:8 row_mask:0xf bank_mask:0x3
    v_mov_b32_dpp v55, v53 row_ror:8 row_mask:0xf bank_mask:0x3
    v_perm_b32 v6, v55, v51, s46
    v_mfma_f32_16x16x32_bf16 v[180:183], v[140:143], v[104:107], v[180:183]
    v_perm_b32 v38, v55, v51, s47
    v_mov_b32_dpp v59, v57 row_ror:8 row_mask:0xf bank_mask:0x3
    v_mov_b32_dpp v63, v61 row_ror:8 row_mask:0xf bank_mask:0x3
    v_mfma_f32_16x16x32_bf16 v[184:187], v[140:143], v[108:111], v[184:187]
    v_perm_b32 v7, v63, v59, s46
    v_perm_b32 v39, v63, v59, s47
    v_mfma_f32_16x16x32_bf16 v[188:191], v[140:143], v[112:115], v[188:191]
    v_add_u32 v11, s99, v12
    ds_read_b128 v[104:107], v11
    ds_read_b128 v[108:111], v11 offset:1024
    ds_read_b128 v[112:115], v11 offset:2048
    s_waitcnt lgkmcnt(3)
    v_mfma_f32_16x16x32_bf16 v[144:147], v[192:195], v[116:119], v[144:147]
    s_waitcnt vmcnt(0)
    v_cndmask_b32_dpp v14, v66, v64, vcc row_ror:8 row_mask:0xf bank_mask:0xf
    v_cndmask_b32_dpp v30, v70, v68, vcc row_ror:8 row_mask:0xf bank_mask:0xf
    v_perm_b32 v128, v30, v14, s46
    v_mfma_f32_16x16x32_bf16 v[148:151], v[192:195], v[120:123], v[148:151]
    v_perm_b32 v132, v30, v14, s47
    v_cndmask_b32_dpp v31, v74, v72, vcc row_ror:8 row_mask:0xf bank_mask:0xf
    v_cndmask_b32_dpp v32, v78, v76, vcc row_ror:8 row_mask:0xf bank_mask:0xf
    v_mfma_f32_16x16x32_bf16 v[152:155], v[192:195], v[124:127], v[152:155]
    v_perm_b32 v129, v32, v31, s46
    v_perm_b32 v133, v32, v31, s47
    v_cndmask_b32_dpp v14, v82, v80, vcc row_ror:8 row_mask:0xf bank_mask:0xf
    v_mfma_f32_16x16x32_bf16 v[156:159], v[196:199], v[116:119], v[156:159]
    v_cndmask_b32_dpp v30, v86, v84, vcc row_ror:8 row_mask:0xf bank_mask:0xf
    v_perm_b32 v130, v30, v14, s46
    v_perm_b32 v134, v30, v14, s47
    v_mfma_f32_16x16x32_bf16 v[160:163], v[196:199], v[120:123], v[160:163]
    v_cndmask_b32_dpp v31, v202, v200, vcc row_ror:8 row_mask:0xf bank_mask:0xf
    v_cndmask_b32_dpp v32, v206, v204, vcc row_ror:8 row_mask:0xf bank_mask:0xf
    v_perm_b32 v131, v32, v31, s46
    v_mfma_f32_16x16x32_bf16 v[164:167], v[196:199], v[124:127], v[164:167]
    v_perm_b32 v135, v32, v31, s47
    v_cndmask_b32_dpp v14, v67, v65, vcc row_ror:8 row_mask:0xf bank_mask:0xf
    v_cndmask_b32_dpp v30, v71, v69, vcc row_ror:8 row_mask:0xf bank_mask:0xf
    v_mfma_f32_16x16x32_bf16 v[168:171], v[4:7], v[116:119], v[168:171]
    v_perm_b32 v136, v30, v14, s46
    v_perm_b32 v140, v30, v14, s47
    v_cndmask_b32_dpp v31, v75, v73, vcc row_ror:8 row_mask:0xf bank_mask:0xf
    v_mfma_f32_16x16x32_bf16 v[172:175], v[4:7], v[120:123], v[172:175]
    v_cndmask_b32_dpp v32, v79, v77, vcc row_ror:8 row_mask:0xf bank_mask:0xf
    v_perm_b32 v137, v32, v31, s46
    v_perm_b32 v141, v32, v31, s47
    v_mfma_f32_16x16x32_bf16 v[176:179], v[4:7], v[124:127], v[176:179]
    v_cndmask_b32_dpp v14, v83, v81, vcc row_ror:8 row_mask:0xf bank_mask:0xf
    v_cndmask_b32_dpp v30, v87, v85, vcc row_ror:8 row_mask:0xf bank_mask:0xf
    v_perm_b32 v138, v30, v14, s46
    v_mfma_f32_16x16x32_bf16 v[180:183], v[36:39], v[116:119], v[180:183]
    v_perm_b32 v142, v30, v14, s47
    v_cndmask_b32_dpp v31, v203, v201, vcc row_ror:8 row_mask:0xf bank_mask:0xf
    v_cndmask_b32_dpp v32, v207, v205, vcc row_ror:8 row_mask:0xf bank_mask:0xf
    v_mfma_f32_16x16x32_bf16 v[184:187], v[36:39], v[120:123], v[184:187]
    v_perm_b32 v139, v32, v31, s46
    v_perm_b32 v143, v32, v31, s47
    v_mfma_f32_16x16x32_bf16 v[188:191], v[36:39], v[124:127], v[188:191]
    ds_read_b128 v[116:119], v11 offset:32768
    ds_read_b128 v[120:123], v11 offset:33792
    ds_read_b128 v[124:127], v11 offset:34816
    s_waitcnt lgkmcnt(3)
    v_mfma_f32_16x16x32_bf16 v[144:147], v[128:131], v[104:107], v[144:147]
    v_mov_b32_dpp v66, v64 row_ror:8 row_mask:0xf bank_mask:0x3
    v_mov_b32_dpp v70, v68 row_ror:8 row_mask:0xf bank_mask:0x3
    v_perm_b32 v192, v70, v66, s46
    v_mfma_f32_16x16x32_bf16 v[148:151], v[128:131], v[108:111], v[148:151]
    v_perm_b32 v196, v70, v66, s47
    v_mov_b32_dpp v74, v72 row_ror:8 row_mask:0xf bank_mask:0x3
    v_mov_b32_dpp v78, v76 row_ror:8 row_mask:0xf bank_mask:0x3
    v_mfma_f32_16x16x32_bf16 v[152:155], v[128:131], v[112:115], v[152:155]
    v_perm_b32 v193, v78, v74, s46
    v_perm_b32 v197, v78, v74, s47
    v_mov_b32_dpp v82, v80 row_ror:8 row_mask:0xf bank_mask:0x3
    v_mfma_f32_16x16x32_bf16 v[156:159], v[132:135], v[104:107], v[156:159]
    v_mov_b32_dpp v86, v84 row_ror:8 row_mask:0xf bank_mask:0x3
    v_perm_b32 v194, v86, v82, s46
    v_perm_b32 v198, v86, v82, s47
    v_mfma_f32_16x16x32_bf16 v[160:163], v[132:135], v[108:111], v[160:163]
    v_mov_b32_dpp v202, v200 row_ror:8 row_mask:0xf bank_mask:0x3
    v_mov_b32_dpp v206, v204 row_ror:8 row_mask:0xf bank_mask:0x3
    v_perm_b32 v195, v206, v202, s46
    v_mfma_f32_16x16x32_bf16 v[164:167], v[132:135], v[112:115], v[164:167]
    v_perm_b32 v199, v206, v202, s47
    v_mov_b32_dpp v67, v65 row_ror:8 row_mask:0xf bank_mask:0x3
    v_mov_b32_dpp v71, v69 row_ror:8 row_mask:0xf bank_mask:0x3
    v_mfma_f32_16x16x32_bf16 v[168:171], v[136:139], v[104:107], v[168:171]
    v_perm_b32 v4, v71, v67, s46
    v_perm_b32 v36, v71, v67, s47
    v_mov_b32_dpp v75, v73 row_ror:8 row_mask:0xf bank_mask:0x3
    v_mfma_f32_16x16x32_bf16 v[172:175], v[136:139], v[108:111], v[172:175]
    v_mov_b32_dpp v79, v77 row_ror:8 row_mask:0xf bank_mask:0x3
    v_perm_b32 v5, v79, v75, s46
    v_perm_b32 v37, v79, v75, s47
    v_mfma_f32_16x16x32_bf16 v[176:179], v[136:139], v[112:115], v[176:179]
    v_mov_b32_dpp v83, v81 row_ror:8 row_mask:0xf bank_mask:0x3
    v_mov_b32_dpp v87, v85 row_ror:8 row_mask:0xf bank_mask:0x3
    v_perm_b32 v6, v87, v83, s46
    v_mfma_f32_16x16x32_bf16 v[180:183], v[140:143], v[104:107], v[180:183]
    v_perm_b32 v38, v87, v83, s47
    v_mov_b32_dpp v203, v201 row_ror:8 row_mask:0xf bank_mask:0x3
    v_mov_b32_dpp v207, v205 row_ror:8 row_mask:0xf bank_mask:0x3
    v_mfma_f32_16x16x32_bf16 v[184:187], v[140:143], v[108:111], v[184:187]
    v_perm_b32 v7, v207, v203, s46
    v_perm_b32 v39, v207, v203, s47
    v_mfma_f32_16x16x32_bf16 v[188:191], v[140:143], v[112:115], v[188:191]
    s_waitcnt lgkmcnt(0)
    v_mfma_f32_16x16x32_bf16 v[144:147], v[192:195], v[116:119], v[144:147]
    v_mfma_f32_16x16x32_bf16 v[148:151], v[192:195], v[120:123], v[148:151]
    v_mfma_f32_16x16x32_bf16 v[152:155], v[192:195], v[124:127], v[152:155]
    v_mfma_f32_16x16x32_bf16 v[156:159], v[196:199], v[116:119], v[156:159]
    v_mfma_f32_16x16x32_bf16 v[160:163], v[196:199], v[120:123], v[160:163]
    v_mfma_f32_16x16x32_bf16 v[164:167], v[196:199], v[124:127], v[164:167]
    v_mfma_f32_16x16x32_bf16 v[168:171], v[4:7], v[116:119], v[168:171]
    v_mfma_f32_16x16x32_bf16 v[172:175], v[4:7], v[120:123], v[172:175]
    v_mfma_f32_16x16x32_bf16 v[176:179], v[4:7], v[124:127], v[176:179]
    v_mfma_f32_16x16x32_bf16 v[180:183], v[36:39], v[116:119], v[180:183]
    v_mfma_f32_16x16x32_bf16 v[184:187], v[36:39], v[120:123], v[184:187]
    v_mfma_f32_16x16x32_bf16 v[188:191], v[36:39], v[124:127], v[188:191]
    s_mul_i32 s51, s56, 0xc000
    s_mul_i32 s52, s40, 0x1800
    s_add_u32 s51, s51, s52
    v_cvt_pk_bf16_f32 v40, v144, v156
    s_nop 1
    v_cvt_pk_bf16_f32 v41, v168, v180
    v_cvt_pk_bf16_f32 v42, v145, v157
    v_cvt_pk_bf16_f32 v43, v169, v181
    buffer_store_dwordx4 v[40:43], v9, s[36:39], s51 offen sc1
    s_lshl_b32 s52, s42, 4
    v_mov_b32 v108, s52
    s_cmp_ge_u32 s40, 3
    s_cbranch_scc1 gqa_fused_noh0
    buffer_load_dword v109, v108, s[64:67], 0 offen sc1
gqa_fused_noh0:
    v_cvt_pk_bf16_f32 v44, v148, v160
    v_cvt_pk_bf16_f32 v45, v172, v184
    v_cvt_pk_bf16_f32 v46, v149, v161
    v_cvt_pk_bf16_f32 v47, v173, v185
    buffer_store_dwordx4 v[44:47], v9, s[36:39], s51 offen offset:1024 sc1
    v_cvt_pk_bf16_f32 v48, v152, v164
    v_cvt_pk_bf16_f32 v49, v176, v188
    v_cvt_pk_bf16_f32 v50, v153, v165
    v_cvt_pk_bf16_f32 v51, v177, v189
    buffer_store_dwordx4 v[48:51], v9, s[36:39], s51 offen offset:2048 sc1
    v_cvt_pk_bf16_f32 v52, v146, v158
    v_cvt_pk_bf16_f32 v53, v170, v182
    v_cvt_pk_bf16_f32 v54, v147, v159
    v_cvt_pk_bf16_f32 v55, v171, v183
    buffer_store_dwordx4 v[52:55], v9, s[36:39], s51 offen offset:3072 sc1
    s_add_u32 s51, s51, 0x1000
    v_cvt_pk_bf16_f32 v56, v150, v162
    v_cvt_pk_bf16_f32 v57, v174, v186
    v_cvt_pk_bf16_f32 v58, v151, v163
    v_cvt_pk_bf16_f32 v59, v175, v187
    buffer_store_dwordx4 v[56:59], v9, s[36:39], s51 offen sc1
    v_cvt_pk_bf16_f32 v60, v154, v166
    v_cvt_pk_bf16_f32 v61, v178, v190
    v_cvt_pk_bf16_f32 v62, v155, v167
    v_cvt_pk_bf16_f32 v63, v179, v191
    buffer_store_dwordx4 v[60:63], v9, s[36:39], s51 offen offset:1024 sc1
    s_waitcnt vmcnt(0) lgkmcnt(0)
gqa_fused_skipop:
    s_barrier
    s_cmp_ge_u32 s40, 3
    s_cbranch_scc1 gqa_fused_fin
    s_cmp_lg_u32 s40, 0
    s_cbranch_scc1 gqa_fused_noflag
    s_lshl_b32 s51, s56, 2
    v_mov_b32 v12, s51
    v_mov_b32 v13, 1
    s_mov_b64 exec, 1
    buffer_store_dword v13, v12, s[92:95], 0 offen sc1
    s_mov_b64 exec, -1
gqa_fused_noflag:
    s_lshl_b32 s51, s42, 4
    v_mov_b32 v12, s51
    s_mov_b32 s52, 0
    v_readfirstlane_b32 s54, v109
    s_nop 0
    s_nop 0
    s_cmp_ge_u32 s54, 16
    s_cbranch_scc1 gqa_fused_poll1a
gqa_fused_poll0:
    buffer_load_dword v13, v12, s[64:67], 0 offen sc1
    s_waitcnt vmcnt(0)
    v_readfirstlane_b32 s54, v13
    s_add_u32 s52, s52, 1
    s_nop 0
    s_cmp_ge_u32 s54, 16
    s_cbranch_scc1 gqa_fused_poll1a
    s_sleep 8
    s_cmp_lt_u32 s52, 0x186a0
    s_cbranch_scc1 gqa_fused_poll0
gqa_fused_poll1a:
    v_lshlrev_b32 v12, 2, v2
    s_mov_b32 s52, 0
    s_mov_b32 s53, 0
    s_mul_i32 s90, s56, 3
    s_add_u32 s90, s90, s40
    s_lshl_b32 s90, s90, 10
gqa_fused_poll1:
    buffer_load_dword v13, v12, s[92:95], 0 offen sc1
    s_waitcnt vmcnt(0)
    v_cmp_eq_u32 vcc, 1, v13
    s_add_u32 s52, s52, 1
    s_nop 1
    s_and_b32 s54, vcc_lo, 0xffff
    s_andn2_b32 s55, s54, s53
    s_or_b32 s53, s53, s54
    s_bitcmp1_b32 s55, 0
    s_cbranch_scc0 gqa_fused_sk0
    s_add_u32 s51, s90, 0
    buffer_load_dwordx4 v[40:43], v9, s[36:39], s51 offen sc1
gqa_fused_sk0:
    s_bitcmp1_b32 s55, 1
    s_cbranch_scc0 gqa_fused_sk1
    s_add_u32 s51, s90, 0xc000
    buffer_load_dwordx4 v[44:47], v9, s[36:39], s51 offen sc1
gqa_fused_sk1:
    s_bitcmp1_b32 s55, 2
    s_cbranch_scc0 gqa_fused_sk2
    s_add_u32 s51, s90, 0x18000
    buffer_load_dwordx4 v[48:51], v9, s[36:39], s51 offen sc1
gqa_fused_sk2:
    s_bitcmp1_b32 s55, 3
    s_cbranch_scc0 gqa_fused_sk3
    s_add_u32 s51, s90, 0x24000
    buffer_load_dwordx4 v[52:55], v9, s[36:39], s51 offen sc1
gqa_fused_sk3:
    s_bitcmp1_b32 s55, 4
    s_cbranch_scc0 gqa_fused_sk4
    s_add_u32 s51, s90, 0x30000
    buffer_load_dwordx4 v[56:59], v9, s[36:39], s51 offen sc1
gqa_fused_sk4:
    s_bitcmp1_b32 s55, 5
    s_cbranch_scc0 gqa_fused_sk5
    s_add_u32 s51, s90, 0x3c000
    buffer_load_dwordx4 v[60:63], v9, s[36:39], s51 offen sc1
gqa_fused_sk5:
    s_bitcmp1_b32 s55, 6
    s_cbranch_scc0 gqa_fused_sk6
    s_add_u32 s51, s90, 0x48000
    buffer_load_dwordx4 v[64:67], v9, s[36:39], s51 offen sc1
gqa_fused_sk6:
    s_bitcmp1_b32 s55, 7
    s_cbranch_scc0 gqa_fused_sk7
    s_add_u32 s51, s90, 0x54000
    buffer_load_dwordx4 v[68:71], v9, s[36:39], s51 offen sc1
gqa_fused_sk7:
    s_bitcmp1_b32 s55, 8
    s_cbranch_scc0 gqa_fused_sk8
    s_add_u32 s51, s90, 0x60000
    buffer_load_dwordx4 v[72:75], v9, s[36:39], s51 offen sc1
gqa_fused_sk8:
    s_bitcmp1_b32 s55, 9
    s_cbranch_scc0 gqa_fused_sk9
    s_add_u32 s51, s90, 0x6c000
    buffer_load_dwordx4 v[76:79], v9, s[36:39], s51 offen sc1
gqa_fused_sk9:
    s_bitcmp1_b32 s55, 10
    s_cbranch_scc0 gqa_fused_sk10
    s_add_u32 s51, s90, 0x78000
    buffer_load_dwordx4 v[80:83], v9, s[36:39], s51 offen sc1
gqa_fused_sk10:
    s_bitcmp1_b32 s55, 11
    s_cbranch_scc0 gqa_fused_sk11
    s_add_u32 s51, s90, 0x84000
    buffer_load_dwordx4 v[84:87], v9, s[36:39], s51 offen sc1
gqa_fused_sk11:
    s_bitcmp1_b32 s55, 12
    s_cbranch_scc0 gqa_fused_sk12
    s_add_u32 s51, s90, 0x90000
    buffer_load_dwordx4 v[88:91], v9, s[36:39], s51 offen sc1
gqa_fused_sk12:
    s_bitcmp1_b32 s55, 13
    s_cbranch_scc0 gqa_fused_sk13
    s_add_u32 s51, s90, 0x9c000
    buffer_load_dwordx4 v[92:95], v9, s[36:39], s51 offen sc1
gqa_fused_sk13:
    s_bitcmp1_b32 s55, 14
    s_cbranch_scc0 gqa_fused_sk14
    s_add_u32 s51, s90, 0xa8000
    buffer_load_dwordx4 v[96:99], v9, s[36:39], s51 offen sc1
gqa_fused_sk14:
    s_bitcmp1_b32 s55, 15
    s_cbranch_scc0 gqa_fused_sk15
    s_add_u32 s51, s90, 0xb4000
    buffer_load_dwordx4 v[100:103], v9, s[36:39], s51 offen sc1
gqa_fused_sk15:
    s_cmp_eq_u32 s53, 0xffff
    s_cbranch_scc1 gqa_fused_alldone
    s_sleep 1
    s_cmp_lt_u32 s52, 0x30d40
    s_cbranch_scc1 gqa_fused_poll1
gqa_fused_alldone:
    s_lshr_b32 s51, s56, 1
    s_lshl_b32 s51, s51, 7
    s_and_b32 s52, s56, 1
    s_lshl_b32 s52, s52, 5
    s_add_u32 s51, s51, s52
    s_lshl_b32 s52, s40, 14
    s_add_u32 s51, s51, s52
    v_and_b32 v12, 1, v3
    v_lshlrev_b32 v12, 6, v12
    v_lshrrev_b32 v13, 1, v3
    v_lshl_add_u32 v12, v13, 3, v12
    v_lshl_add_u32 v12, v2, 10, v12
    s_mov_b32 s54, 0xffff0000
    s_waitcnt vmcnt(0)
    v_lshlrev_b32 v120, 16, v40
    v_and_b32 v124, s54, v40
    v_lshlrev_b32 v121, 16, v41
    v_and_b32 v125, s54, v41
    v_lshlrev_b32 v122, 16, v42
    v_and_b32 v126, s54, v42
    v_lshlrev_b32 v123, 16, v43
    v_and_b32 v127, s54, v43
    v_lshlrev_b32 v128, 16, v44
    v_and_b32 v132, s54, v44
    v_add_f32 v120, v120, v128
    v_add_f32 v124, v124, v132
    v_lshlrev_b32 v129, 16, v45
    v_and_b32 v133, s54, v45
    v_add_f32 v121, v121, v129
    v_add_f32 v125, v125, v133
    v_lshlrev_b32 v130, 16, v46
    v_and_b32 v134, s54, v46
    v_add_f32 v122, v122, v130
    v_add_f32 v126, v126, v134
    v_lshlrev_b32 v131, 16, v47
    v_and_b32 v135, s54, v47
    v_add_f32 v123, v123, v131
    v_add_f32 v127, v127, v135
    v_lshlrev_b32 v128, 16, v48
    v_and_b32 v132, s54, v48
    v_add_f32 v120, v120, v128
    v_add_f32 v124, v124, v132
    v_lshlrev_b32 v129, 16, v49
    v_and_b32 v133, s54, v49
    v_add_f32 v121, v121, v129
    v_add_f32 v125, v125, v133
    v_lshlrev_b32 v130, 16, v50
    v_and_b32 v134, s54, v50
    v_add_f32 v122, v122, v130
    v_add_f32 v126, v126, v134
    v_lshlrev_b32 v131, 16, v51
    v_and_b32 v135, s54, v51
    v_add_f32 v123, v123, v131
    v_add_f32 v127, v127, v135
    v_lshlrev_b32 v128, 16, v52
    v_and_b32 v132, s54, v52
    v_add_f32 v120, v120, v128
    v_add_f32 v124, v124, v132
    v_lshlrev_b32 v129, 16, v53
    v_and_b32 v133, s54, v53
    v_add_f32 v121, v121, v129
    v_add_f32 v125, v125, v133
    v_lshlrev_b32 v130, 16, v54
    v_and_b32 v134, s54, v54
    v_add_f32 v122, v122, v130
    v_add_f32 v126, v126, v134
    v_lshlrev_b32 v131, 16, v55
    v_and_b32 v135, s54, v55
    v_add_f32 v123, v123, v131
    v_add_f32 v127, v127, v135
    v_lshlrev_b32 v128, 16, v56
    v_and_b32 v132, s54, v56
    v_add_f32 v120, v120, v128
    v_add_f32 v124, v124, v132
    v_lshlrev_b32 v129, 16, v57
    v_and_b32 v133, s54, v57
    v_add_f32 v121, v121, v129
    v_add_f32 v125, v125, v133
    v_lshlrev_b32 v130, 16, v58
    v_and_b32 v134, s54, v58
    v_add_f32 v122, v122, v130
    v_add_f32 v126, v126, v134
    v_lshlrev_b32 v131, 16, v59
    v_and_b32 v135, s54, v59
    v_add_f32 v123, v123, v131
    v_add_f32 v127, v127, v135
    v_lshlrev_b32 v128, 16, v60
    v_and_b32 v132, s54, v60
    v_add_f32 v120, v120, v128
    v_add_f32 v124, v124, v132
    v_lshlrev_b32 v129, 16, v61
    v_and_b32 v133, s54, v61
    v_add_f32 v121, v121, v129
    v_add_f32 v125, v125, v133
    v_lshlrev_b32 v130, 16, v62
    v_and_b32 v134, s54, v62
    v_add_f32 v122, v122, v130
    v_add_f32 v126, v126, v134
    v_lshlrev_b32 v131, 16, v63
    v_and_b32 v135, s54, v63
    v_add_f32 v123, v123, v131
    v_add_f32 v127, v127, v135
    v_lshlrev_b32 v128, 16, v64
    v_and_b32 v132, s54, v64
    v_add_f32 v120, v120, v128
    v_add_f32 v124, v124, v132
    v_lshlrev_b32 v129, 16, v65
    v_and_b32 v133, s54, v65
    v_add_f32 v121, v121, v129
    v_add_f32 v125, v125, v133
    v_lshlrev_b32 v130, 16, v66
    v_and_b32 v134, s54, v66
    v_add_f32 v122, v122, v130
    v_add_f32 v126, v126, v134
    v_lshlrev_b32 v131, 16, v67
    v_and_b32 v135, s54, v67
    v_add_f32 v123, v123, v131
    v_add_f32 v127, v127, v135
    v_lshlrev_b32 v128, 16, v68
    v_and_b32 v132, s54, v68
    v_add_f32 v120, v120, v128
    v_add_f32 v124, v124, v132
    v_lshlrev_b32 v129, 16, v69
    v_and_b32 v133, s54, v69
    v_add_f32 v121, v121, v129
    v_add_f32 v125, v125, v133
    v_lshlrev_b32 v130, 16, v70
    v_and_b32 v134, s54, v70
    v_add_f32 v122, v122, v130
    v_add_f32 v126, v126, v134
    v_lshlrev_b32 v131, 16, v71
    v_and_b32 v135, s54, v71
    v_add_f32 v123, v123, v131
    v_add_f32 v127, v127, v135
    v_lshlrev_b32 v128, 16, v72
    v_and_b32 v132, s54, v72
    v_add_f32 v120, v120, v128
    v_add_f32 v124, v124, v132
    v_lshlrev_b32 v129, 16, v73
    v_and_b32 v133, s54, v73
    v_add_f32 v121, v121, v129
    v_add_f32 v125, v125, v133
    v_lshlrev_b32 v130, 16, v74
    v_and_b32 v134, s54, v74
    v_add_f32 v122, v122, v130
    v_add_f32 v126, v126, v134
    v_lshlrev_b32 v131, 16, v75
    v_and_b32 v135, s54, v75
    v_add_f32 v123, v123, v131
    v_add_f32 v127, v127, v135
    v_lshlrev_b32 v128, 16, v76
    v_and_b32 v132, s54, v76
    v_add_f32 v120, v120, v128
    v_add_f32 v124, v124, v132
    v_lshlrev_b32 v129, 16, v77
    v_and_b32 v133, s54, v77
    v_add_f32 v121, v121, v129
    v_add_f32 v125, v125, v133
    v_lshlrev_b32 v130, 16, v78
    v_and_b32 v134, s54, v78
    v_add_f32 v122, v122, v130
    v_add_f32 v126, v126, v134
    v_lshlrev_b32 v131, 16, v79
    v_and_b32 v135, s54, v79
    v_add_f32 v123, v123, v131
    v_add_f32 v127, v127, v135
    v_lshlrev_b32 v128, 16, v80
    v_and_b32 v132, s54, v80
    v_add_f32 v120, v120, v128
    v_add_f32 v124, v124, v132
    v_lshlrev_b32 v129, 16, v81
    v_and_b32 v133, s54, v81
    v_add_f32 v121, v121, v129
    v_add_f32 v125, v125, v133
    v_lshlrev_b32 v130, 16, v82
    v_and_b32 v134, s54, v82
    v_add_f32 v122, v122, v130
    v_add_f32 v126, v126, v134
    v_lshlrev_b32 v131, 16, v83
    v_and_b32 v135, s54, v83
    v_add_f32 v123, v123, v131
    v_add_f32 v127, v127, v135
    v_lshlrev_b32 v128, 16, v84
    v_and_b32 v132, s54, v84
    v_add_f32 v120, v120, v128
    v_add_f32 v124, v124, v132
    v_lshlrev_b32 v129, 16, v85
    v_and_b32 v133, s54, v85
    v_add_f32 v121, v121, v129
    v_add_f32 v125, v125, v133
    v_lshlrev_b32 v130, 16, v86
    v_and_b32 v134, s54, v86
    v_add_f32 v122, v122, v130
    v_add_f32 v126, v126, v134
    v_lshlrev_b32 v131, 16, v87
    v_and_b32 v135, s54, v87
    v_add_f32 v123, v123, v131
    v_add_f32 v127, v127, v135
    v_lshlrev_b32 v128, 16, v88
    v_and_b32 v132, s54, v88
    v_add_f32 v120, v120, v128
    v_add_f32 v124, v124, v132
    v_lshlrev_b32 v129, 16, v89
    v_and_b32 v133, s54, v89
    v_add_f32 v121, v121, v129
    v_add_f32 v125, v125, v133
    v_lshlrev_b32 v130, 16, v90
    v_and_b32 v134, s54, v90
    v_add_f32 v122, v122, v130
    v_add_f32 v126, v126, v134
    v_lshlrev_b32 v131, 16, v91
    v_and_b32 v135, s54, v91
    v_add_f32 v123, v123, v131
    v_add_f32 v127, v127, v135
    v_lshlrev_b32 v128, 16, v92
    v_and_b32 v132, s54, v92
    v_add_f32 v120, v120, v128
    v_add_f32 v124, v124, v132
    v_lshlrev_b32 v129, 16, v93
    v_and_b32 v133, s54, v93
    v_add_f32 v121, v121, v129
    v_add_f32 v125, v125, v133
    v_lshlrev_b32 v130, 16, v94
    v_and_b32 v134, s54, v94
    v_add_f32 v122, v122, v130
    v_add_f32 v126, v126, v134
    v_lshlrev_b32 v131, 16, v95
    v_and_b32 v135, s54, v95
    v_add_f32 v123, v123, v131
    v_add_f32 v127, v127, v135
    v_lshlrev_b32 v128, 16, v96
    v_and_b32 v132, s54, v96
    v_add_f32 v120, v120, v128
    v_add_f32 v124, v124, v132
    v_lshlrev_b32 v129, 16, v97
    v_and_b32 v133, s54, v97
    v_add_f32 v121, v121, v129
    v_add_f32 v125, v125, v133
    v_lshlrev_b32 v130, 16, v98
    v_and_b32 v134, s54, v98
    v_add_f32 v122, v122, v130
    v_add_f32 v126, v126, v134
    v_lshlrev_b32 v131, 16, v99
    v_and_b32 v135, s54, v99
    v_add_f32 v123, v123, v131
    v_add_f32 v127, v127, v135
    v_lshlrev_b32 v128, 16, v100
    v_and_b32 v132, s54, v100
    v_add_f32 v120, v120, v128
    v_add_f32 v124, v124, v132
    v_lshlrev_b32 v129, 16, v101
    v_and_b32 v133, s54, v101
    v_add_f32 v121, v121, v129
    v_add_f32 v125, v125, v133
    v_lshlrev_b32 v130, 16, v102
    v_and_b32 v134, s54, v102
    v_add_f32 v122, v122, v130
    v_add_f32 v126, v126, v134
    v_lshlrev_b32 v131, 16, v103
    v_and_b32 v135, s54, v103
    v_add_f32 v123, v123, v131
    v_add_f32 v127, v127, v135
    v_cvt_pk_bf16_f32 v128, v120, v124
    v_cvt_pk_bf16_f32 v129, v121, v125
    v_cvt_pk_bf16_f32 v130, v122, v126
    v_cvt_pk_bf16_f32 v131, v123, v127
    buffer_store_dwordx2 v[128:129], v12, s[68:71], s51 offen
    buffer_store_dwordx2 v[130:131], v12, s[68:71], s51 offen offset:16
gqa_fused_fin:
gqa_fused_end:
    s_endpgm
.section .rodata,"a"
.p2align 6
.amdhsa_kernel standalone__gqa_block_cached__near_ridge_kernel
  .amdhsa_next_free_vgpr 256
  .amdhsa_next_free_sgpr 102
  .amdhsa_accum_offset 256
  .amdhsa_group_segment_fixed_size 0
  .amdhsa_kernarg_size 64
  .amdhsa_user_sgpr_count 2
  .amdhsa_user_sgpr_kernarg_segment_ptr 1
  .amdhsa_system_sgpr_workgroup_id_x 1
.end_amdhsa_kernel
```
